```python
import torch

def _softmax(x, axis=-1):
    return torch.softmax(x, dim=axis)
def _gelu(x):
    return torch.nn.functional.gelu(x, approximate="tanh")
def _silu(x):
    return torch.nn.functional.silu(x)
def _sigmoid(x):
    return torch.sigmoid(x)
def _layernorm(x, axis=-1, eps=1e-5):
    m = x.mean(dim=axis, keepdim=True)
    v = x.var(dim=axis, keepdim=True, unbiased=False)
    return (x - m) / torch.sqrt(v + eps)
def _scatter_add(tgt, idx, src, axis=0):
    return tgt.clone().index_add_(axis, idx, src)
def _segment_sum(src, seg, n):
    out = torch.zeros((n,) + src.shape[1:], dtype=src.dtype)
    return out.index_add_(0, seg, src)
def _pad(x, pw):
    flat = tuple(v for pair in reversed(pw) for v in pair)
    return torch.nn.functional.pad(x, flat)

kernel_name = 'sequential_preLN__mha_block_cached__geglu_ffn__decode'

def setup_inputs():

    _w = (lambda a: (lambda t: t.to(torch.bfloat16) if t.is_floating_point() else t)(torch.as_tensor(a)))
    def _A_setup():
        B, Sq, D = 2, 1, 448
        H, Sk, Dh = 16, 16384, 256
        return {
            "x": _w((lambda *s: torch.randn(*s, dtype=torch.bfloat16) * 0.05)(B, Sq, D)),
            "k_cache": _w((lambda *s: torch.randn(*s, dtype=torch.bfloat16) * 3.2)(B, H, Sk, Dh)),
            "v_cache": _w((lambda *s: torch.randn(*s, dtype=torch.bfloat16) * 0.4)(B, H, Sk, Dh)),
            "wq": _w((lambda *s: torch.randn(*s, dtype=torch.bfloat16) * 3.2)(D, H * Dh) * (D ** -0.5)),
            "wo": _w((lambda *s: torch.randn(*s, dtype=torch.bfloat16) * 0.4)(H * Dh, D) * ((H * Dh) ** -0.5)),
        }
    _A_in = _A_setup()

    def _B_setup():
        B, S, D, F = 2, 1, 448, 1792
        return {
            "x": _w((lambda *s: torch.randn(*s, dtype=torch.bfloat16) * 0.05)(B, S, D)),
            "w_gate": _w((lambda *s: torch.randn(*s, dtype=torch.bfloat16) * 0.05)(D, F)),
            "w_up": _w((lambda *s: torch.randn(*s, dtype=torch.bfloat16) * 0.05)(D, F)),
            "w_down": _w((lambda *s: torch.randn(*s, dtype=torch.bfloat16) * 0.05)(F, D)),
        }
    _B_in = _B_setup()

    return {
        "A_x": _A_in["x"],
        "A_k_cache": _A_in["k_cache"],
        "A_v_cache": _A_in["v_cache"],
        "A_wq": _A_in["wq"],
        "A_wo": _A_in["wo"],
        "B_x": _B_in["x"],
        "B_w_gate": _B_in["w_gate"],
        "B_w_up": _B_in["w_up"],
        "B_w_down": _B_in["w_down"],
    }

def reference(A_x, A_k_cache, A_v_cache, A_wq, A_wo, B_x, B_w_gate, B_w_up, B_w_down):
    def _A_ref(x, k_cache, v_cache, wq, wo):
        B, Sq, D = x.shape
        H, Dh = 16, 256
        q = (lambda x, *d: x.permute(*d))((x @ wq).reshape(B, Sq, H, Dh), 0, 2, 1, 3)
        scores = torch.einsum("bhqd,bhkd->bhqk", q, k_cache) * (Dh ** -0.5)
        p = _softmax(scores, axis=-1)
        o = torch.einsum("bhqk,bhkd->bhqd", p, v_cache)
        return (lambda x, *d: x.permute(*d))(o, 0, 2, 1, 3).reshape(B, Sq, H * Dh) @ wo

    def _B_ref(x, w_gate, w_up, w_down):
        return (_gelu(x @ w_gate) * (x @ w_up)) @ w_down

    x = A_x
    h = x + _A_ref(_layernorm(x, axis=-1), A_k_cache, A_v_cache, A_wq, A_wo)
    h2 = h + _B_ref(_layernorm(h, axis=-1), B_w_gate, B_w_up, B_w_down)
    return h2
```

```asm
; @launch grid=(256,1,1) block=(256,1,1) lds=118784
.amdgcn_target "amdgcn-amd-amdhsa--gfx950"
.text
.globl sequential_preLN__mha_block_cached__geglu_ffn__decode_kernel
.p2align 8
.type sequential_preLN__mha_block_cached__geglu_ffn__decode_kernel,@function
sequential_preLN__mha_block_cached__geglu_ffn__decode_kernel:
    s_cmp_ge_u32 s2, 256
    s_cbranch_scc1 .Lend
    s_load_dwordx16 s[4:19], s[0:1], 0
    s_load_dwordx8 s[20:27], s[0:1], 64
    v_and_b32 v1, 63, v0
    v_lshrrev_b32 v2, 6, v0
    s_and_b32 s53, s2, 7
    v_readfirstlane_b32 s52, v2
    s_lshr_b32 s54, s2, 3
    s_mul_i32 s61, s54, 262144
    v_lshrrev_b32 v20, 3, v1
    v_lshlrev_b32 v2, 9, v20
    v_and_b32 v3, 7, v1
    v_lshlrev_b32 v13, 13, v20
    v_lshl_or_b32 v2, v3, 4, v2
    v_lshl_or_b32 v13, v3, 4, v13
    v_add_u32 v3, 8192, v2
    v_add_u32 v4, 16384, v2
    v_add_u32 v5, 24576, v2
    s_lshl_b32 s58, s53, 2
    s_add_u32 s58, s58, s52
    s_mov_b32 s56, s58
    s_lshr_b32 s57, s56, 1
    s_lshl_b32 s57, s57, 15
    s_add_u32 s57, s57, s61
    s_and_b32 s63, s56, 1
    s_lshl_b32 s63, s63, 12
    s_add_u32 s57, s57, s63
    s_and_b32 s57, s57, 0x7fffff
    s_mov_b32 s30, 0x800000
    s_mov_b32 s31, 0x20000
    s_lshr_b32 s96, s53, 2
    s_lshl_b32 s60, s54, 1
    s_add_u32 s96, s96, s60
    s_mul_i32 s60, s52, 917504
    s_lshl_b32 s63, s96, 7
    s_add_u32 s60, s60, s63
    v_add_u32 v13, s60, v13
    v_and_b32 v16, 31, v1
    v_cmp_gt_u32 s[64:65], 28, v16
    v_lshrrev_b32 v14, 5, v1
    v_mul_u32_u24 v14, 896, v14
    v_lshl_add_u32 v28, v16, 5, v14
    v_mov_b32 v16, 0x10000
    v_cndmask_b32 v16, v16, v28, s[64:65]
    v_mov_b32 v15, 0
    s_mov_b32 s38, 2883584
    s_mov_b32 s39, 0x20000
    s_mov_b32 s42, 1792
    s_mov_b32 s43, 0x20000
    s_mov_b32 s46, 3670016
    s_mov_b32 s47, 0x20000
    s_mul_i32 s97, s52, 14336
    s_add_u32 s97, s97, 32768
    s_lshl_b32 s60, s54, 23
    s_xor_b32 s62, s53, s54
    s_and_b32 s62, s62, 3
    s_waitcnt lgkmcnt(0)
    s_cbranch_scc1 .Lnoprod1
    s_setprio 3
    s_mov_b64 s[40:41], s[4:5]
    s_mov_b64 s[44:45], s[10:11]
    s_and_b32 s63, s96, 3
    s_or_b32 s63, s63, s52
    s_cbranch_scc1 .Lnocinit
    s_mov_b64 s[36:37], s[26:27]
    s_lshl_b32 s63, s96, 6
    v_and_b32 v14, 1, v1
    v_lshlrev_b32 v14, 12, v14
    v_lshrrev_b32 v17, 1, v1
    v_lshl_add_u32 v14, v17, 7, v14
    v_add_u32 v14, 4096, v14
    s_mov_b64 exec, 15
    buffer_store_dword v15, v14, s[36:39], s63 offen sc1
    s_mov_b64 exec, -1
.Lnocinit:
    buffer_load_dwordx4 v[240:243], v16, s[40:43], 0 offen
    buffer_load_dwordx4 v[244:247], v16, s[40:43], 0 offen offset:16
    s_mov_b32 m0, s97
    s_mov_b32 s63, 0
    buffer_load_dwordx4 v13, s[44:47], s63 offen nt lds
    s_add_u32 s97, s97, 1024
    s_mov_b32 m0, s97
    s_mov_b32 s63, 65536
    buffer_load_dwordx4 v13, s[44:47], s63 offen nt lds
    s_add_u32 s97, s97, 1024
    s_mov_b32 m0, s97
    s_mov_b32 s63, 131072
    buffer_load_dwordx4 v13, s[44:47], s63 offen nt lds
    s_add_u32 s97, s97, 1024
    s_mov_b32 m0, s97
    s_mov_b32 s63, 196608
    buffer_load_dwordx4 v13, s[44:47], s63 offen nt lds
    s_add_u32 s97, s97, 1024
    s_mov_b32 m0, s97
    s_mov_b32 s63, 262144
    buffer_load_dwordx4 v13, s[44:47], s63 offen nt lds
    s_add_u32 s97, s97, 1024
    s_mov_b32 m0, s97
    s_mov_b32 s63, 327680
    buffer_load_dwordx4 v13, s[44:47], s63 offen nt lds
    s_add_u32 s97, s97, 1024
    s_mov_b32 m0, s97
    s_mov_b32 s63, 393216
    buffer_load_dwordx4 v13, s[44:47], s63 offen nt lds
    s_add_u32 s97, s97, 1024
    s_mov_b32 m0, s97
    s_mov_b32 s63, 458752
    buffer_load_dwordx4 v13, s[44:47], s63 offen nt lds
    s_add_u32 s97, s97, 1024
    s_mov_b32 m0, s97
    s_mov_b32 s63, 524288
    buffer_load_dwordx4 v13, s[44:47], s63 offen nt lds
    s_add_u32 s97, s97, 1024
    s_mov_b32 m0, s97
    s_mov_b32 s63, 589824
    buffer_load_dwordx4 v13, s[44:47], s63 offen nt lds
    s_add_u32 s97, s97, 1024
    s_mov_b32 m0, s97
    s_mov_b32 s63, 655360
    buffer_load_dwordx4 v13, s[44:47], s63 offen nt lds
    s_add_u32 s97, s97, 1024
    s_mov_b32 m0, s97
    s_mov_b32 s63, 720896
    buffer_load_dwordx4 v13, s[44:47], s63 offen nt lds
    s_add_u32 s97, s97, 1024
    s_mov_b32 m0, s97
    s_mov_b32 s63, 786432
    buffer_load_dwordx4 v13, s[44:47], s63 offen nt lds
    s_add_u32 s97, s97, 1024
    s_mov_b32 m0, s97
    s_mov_b32 s63, 851968
    buffer_load_dwordx4 v13, s[44:47], s63 offen nt lds
    s_add_u32 s28, s6, s60
    s_addc_u32 s29, s7, 0
    s_branch .Lprod2
.Lnoprod1:
    s_add_u32 s28, s6, s60
    s_addc_u32 s29, s7, 0
    buffer_load_dwordx4 v[64:67], v2, s[28:31], s57 offen offset:0 nt
    buffer_load_dwordx4 v[68:71], v2, s[28:31], s57 offen offset:128 nt
    buffer_load_dwordx4 v[72:75], v2, s[28:31], s57 offen offset:256 nt
    buffer_load_dwordx4 v[76:79], v2, s[28:31], s57 offen offset:384 nt
    buffer_load_dwordx4 v[80:83], v3, s[28:31], s57 offen offset:0 nt
    buffer_load_dwordx4 v[84:87], v3, s[28:31], s57 offen offset:128 nt
    buffer_load_dwordx4 v[88:91], v3, s[28:31], s57 offen offset:256 nt
    buffer_load_dwordx4 v[92:95], v3, s[28:31], s57 offen offset:384 nt
    buffer_load_dwordx4 v[96:99], v4, s[28:31], s57 offen offset:0 nt
    buffer_load_dwordx4 v[100:103], v4, s[28:31], s57 offen offset:128 nt
    buffer_load_dwordx4 v[104:107], v4, s[28:31], s57 offen offset:256 nt
    buffer_load_dwordx4 v[108:111], v4, s[28:31], s57 offen offset:384 nt
    buffer_load_dwordx4 v[112:115], v5, s[28:31], s57 offen offset:0 nt
    buffer_load_dwordx4 v[116:119], v5, s[28:31], s57 offen offset:128 nt
    buffer_load_dwordx4 v[120:123], v5, s[28:31], s57 offen offset:256 nt
    buffer_load_dwordx4 v[124:127], v5, s[28:31], s57 offen offset:384 nt
.Lprod2:
    s_load_dword s68, s[26:27], 0
    s_add_u32 s32, s8, s60
    s_addc_u32 s33, s9, 0
    s_mov_b32 s34, 0x800000
    s_mov_b32 s35, 0x20000
    s_mov_b64 s[36:37], s[26:27]
    s_mov_b32 s48, s24
    s_mov_b32 s49, s25
    s_mov_b32 s50, 256
    s_mov_b32 s51, 0x20000
    s_mov_b32 s59, 0x3db8aa3b
    v_and_b32 v6, 1, v1
    v_mov_b32 v10, 0xffff
    v_lshlrev_b32 v6, 4, v6
    v_lshlrev_b32 v10, v6, v10
    v_bfe_u32 v11, v1, 1, 2
    v_cmp_eq_u32 vcc, 0, v11
    s_nop 1
    v_cndmask_b32 v6, 0, v10, vcc
    v_cmp_eq_u32 vcc, 1, v11
    s_nop 1
    v_cndmask_b32 v7, 0, v10, vcc
    v_cmp_eq_u32 vcc, 2, v11
    s_nop 1
    v_cndmask_b32 v8, 0, v10, vcc
    v_cmp_eq_u32 vcc, 3, v11
    s_nop 1
    v_cndmask_b32 v9, 0, v10, vcc
    s_lshl_b32 s60, s54, 8
    s_add_u32 s60, s60, 4096
    v_mov_b32 v21, s60
    s_lshl_b32 s60, s52, 11
    s_add_u32 s60, s60, 4096
    v_lshl_add_u32 v19, v20, 3, s60
    v_lshl_add_u32 v27, v1, 4, s60
    v_mov_b32 v32, 0xff80ff80
    v_mov_b32 v33, 0xff80ff80
    v_mov_b32 v34, 0xff80ff80
    v_mov_b32 v35, 0xff80ff80
    ds_write_b128 v27, v[32:35]
    ds_write_b128 v27, v[32:35] offset:1024
    s_lshl_b32 s60, s54, 13
    s_add_u32 s60, s60, 524288
    v_lshl_add_u32 v20, v20, 3, s60
    v_lshrrev_b32 v11, 4, v1
    v_bfe_u32 v29, v1, 2, 2
    v_lshl_add_u32 v29, v11, 3, v29
    v_and_b32 v31, 3, v1
    v_and_b32 v10, 1, v1
    v_mul_u32_u24 v30, 896, v10
    v_lshl_add_u32 v30, v11, 4, v30
    s_cmp_eq_u32 s52, 0
    s_cselect_b32 s63, 0, 0
    s_lshl_b32 s60, s63, 5
    s_sub_u32 s60, 0, s60
    v_lshl_add_u32 v23, v1, 5, s58
    v_add_u32 v10, s60, v23
    v_cmp_le_u32 vcc, 2, v1
    s_nop 1
    v_cndmask_b32 v23, v23, v10, vcc
    s_cmp_lg_u32 s62, 0
    s_cbranch_scc1 .Ljoin
    v_lshlrev_b32 v17, 7, v29
    v_lshl_add_u32 v17, v31, 3, v17
    s_lshl_b32 s60, s52, 5
    s_add_u32 s60, s60, 32768
    v_add_u32 v17, s60, v17
    s_waitcnt vmcnt(14)
    v_and_b32 v185, 0xffff0000, v240
    v_lshlrev_b32 v184, 16, v240
    v_and_b32 v187, 0xffff0000, v241
    v_lshlrev_b32 v186, 16, v241
    v_and_b32 v189, 0xffff0000, v242
    v_lshlrev_b32 v188, 16, v242
    v_and_b32 v191, 0xffff0000, v243
    v_lshlrev_b32 v190, 16, v243
    v_and_b32 v193, 0xffff0000, v244
    v_lshlrev_b32 v192, 16, v244
    v_and_b32 v195, 0xffff0000, v245
    v_lshlrev_b32 v194, 16, v245
    v_and_b32 v197, 0xffff0000, v246
    v_lshlrev_b32 v196, 16, v246
    v_and_b32 v199, 0xffff0000, v247
    v_lshlrev_b32 v198, 16, v247
    v_add_f32 v200, v184, v185
    v_add_f32 v201, v186, v187
    v_add_f32 v200, v200, v188
    v_add_f32 v201, v201, v189
    v_add_f32 v200, v200, v190
    v_add_f32 v201, v201, v191
    v_add_f32 v200, v200, v192
    v_add_f32 v201, v201, v193
    v_add_f32 v200, v200, v194
    v_add_f32 v201, v201, v195
    v_add_f32 v200, v200, v196
    v_add_f32 v201, v201, v197
    v_add_f32 v200, v200, v198
    v_add_f32 v201, v201, v199
    v_add_f32 v200, v200, v201
    s_nop 1
    v_add_f32_dpp v200, v200, v200 quad_perm:[1,0,3,2] row_mask:0xf bank_mask:0xf
    s_nop 1
    v_add_f32_dpp v200, v200, v200 quad_perm:[2,3,0,1] row_mask:0xf bank_mask:0xf
    s_nop 1
    v_add_f32_dpp v200, v200, v200 row_half_mirror row_mask:0xf bank_mask:0xf
    s_nop 1
    v_add_f32_dpp v200, v200, v200 row_mirror row_mask:0xf bank_mask:0xf
    s_nop 0
    v_mov_b32 v201, v200
    s_nop 1
    v_permlane16_swap_b32 v200, v201
    s_nop 1
    v_add_f32 v200, v200, v201
    v_mul_f32 v200, 0x3b124925, v200
    v_cvt_pk_bf16_f32 v202, v200, v200
    v_and_b32 v202, 0xffff0000, v202
    v_sub_f32 v206, v184, v200
    v_sub_f32 v207, v185, v200
    v_mul_f32 v204, v206, v206
    v_mul_f32 v205, v207, v207
    v_sub_f32 v206, v186, v200
    v_sub_f32 v207, v187, v200
    v_fmac_f32 v204, v206, v206
    v_fmac_f32 v205, v207, v207
    v_sub_f32 v206, v188, v200
    v_sub_f32 v207, v189, v200
    v_fmac_f32 v204, v206, v206
    v_fmac_f32 v205, v207, v207
    v_sub_f32 v206, v190, v200
    v_sub_f32 v207, v191, v200
    v_fmac_f32 v204, v206, v206
    v_fmac_f32 v205, v207, v207
    v_sub_f32 v206, v192, v200
    v_sub_f32 v207, v193, v200
    v_fmac_f32 v204, v206, v206
    v_fmac_f32 v205, v207, v207
    v_sub_f32 v206, v194, v200
    v_sub_f32 v207, v195, v200
    v_fmac_f32 v204, v206, v206
    v_fmac_f32 v205, v207, v207
    v_sub_f32 v206, v196, v200
    v_sub_f32 v207, v197, v200
    v_fmac_f32 v204, v206, v206
    v_fmac_f32 v205, v207, v207
    v_sub_f32 v206, v198, v200
    v_sub_f32 v207, v199, v200
    v_fmac_f32 v204, v206, v206
    v_fmac_f32 v205, v207, v207
    v_add_f32 v204, v204, v205
    v_cndmask_b32 v204, 0, v204, s[64:65]
    s_nop 1
    v_add_f32_dpp v204, v204, v204 quad_perm:[1,0,3,2] row_mask:0xf bank_mask:0xf
    s_nop 1
    v_add_f32_dpp v204, v204, v204 quad_perm:[2,3,0,1] row_mask:0xf bank_mask:0xf
    s_nop 1
    v_add_f32_dpp v204, v204, v204 row_half_mirror row_mask:0xf bank_mask:0xf
    s_nop 1
    v_add_f32_dpp v204, v204, v204 row_mirror row_mask:0xf bank_mask:0xf
    s_nop 0
    v_mov_b32 v205, v204
    s_nop 1
    v_permlane16_swap_b32 v204, v205
    s_nop 1
    v_add_f32 v204, v204, v205
    v_mul_f32 v204, 0x3b124925, v204
    v_cvt_pk_bf16_f32 v204, v204, v204
    v_and_b32 v204, 0xffff0000, v204
    v_add_f32 v204, 0x3727c5ac, v204
    v_cvt_pk_bf16_f32 v204, v204, v204
    v_and_b32 v204, 0xffff0000, v204
    v_sqrt_f32 v204, v204
    s_nop 0
    v_cvt_pk_bf16_f32 v204, v204, v204
    v_and_b32 v204, 0xffff0000, v204
    v_rcp_f32 v203, v204
    v_sub_f32 v184, v184, v202
    v_sub_f32 v185, v185, v202
    v_cvt_pk_bf16_f32 v206, v184, v185
    v_lshlrev_b32 v184, 16, v206
    v_and_b32 v185, 0xffff0000, v206
    v_mul_f32 v184, v184, v203
    v_mul_f32 v185, v185, v203
    v_cvt_pk_bf16_f32 v184, v184, v185
    v_sub_f32 v186, v186, v202
    v_sub_f32 v187, v187, v202
    v_cvt_pk_bf16_f32 v206, v186, v187
    v_lshlrev_b32 v186, 16, v206
    v_and_b32 v187, 0xffff0000, v206
    v_mul_f32 v186, v186, v203
    v_mul_f32 v187, v187, v203
    v_cvt_pk_bf16_f32 v185, v186, v187
    v_sub_f32 v188, v188, v202
    v_sub_f32 v189, v189, v202
    v_cvt_pk_bf16_f32 v206, v188, v189
    v_lshlrev_b32 v188, 16, v206
    v_and_b32 v189, 0xffff0000, v206
    v_mul_f32 v188, v188, v203
    v_mul_f32 v189, v189, v203
    v_cvt_pk_bf16_f32 v186, v188, v189
    v_sub_f32 v190, v190, v202
    v_sub_f32 v191, v191, v202
    v_cvt_pk_bf16_f32 v206, v190, v191
    v_lshlrev_b32 v190, 16, v206
    v_and_b32 v191, 0xffff0000, v206
    v_mul_f32 v190, v190, v203
    v_mul_f32 v191, v191, v203
    v_cvt_pk_bf16_f32 v187, v190, v191
    v_sub_f32 v192, v192, v202
    v_sub_f32 v193, v193, v202
    v_cvt_pk_bf16_f32 v206, v192, v193
    v_lshlrev_b32 v192, 16, v206
    v_and_b32 v193, 0xffff0000, v206
    v_mul_f32 v192, v192, v203
    v_mul_f32 v193, v193, v203
    v_cvt_pk_bf16_f32 v188, v192, v193
    v_sub_f32 v194, v194, v202
    v_sub_f32 v195, v195, v202
    v_cvt_pk_bf16_f32 v206, v194, v195
    v_lshlrev_b32 v194, 16, v206
    v_and_b32 v195, 0xffff0000, v206
    v_mul_f32 v194, v194, v203
    v_mul_f32 v195, v195, v203
    v_cvt_pk_bf16_f32 v189, v194, v195
    v_sub_f32 v196, v196, v202
    v_sub_f32 v197, v197, v202
    v_cvt_pk_bf16_f32 v206, v196, v197
    v_lshlrev_b32 v196, 16, v206
    v_and_b32 v197, 0xffff0000, v206
    v_mul_f32 v196, v196, v203
    v_mul_f32 v197, v197, v203
    v_cvt_pk_bf16_f32 v190, v196, v197
    v_sub_f32 v198, v198, v202
    v_sub_f32 v199, v199, v202
    v_cvt_pk_bf16_f32 v206, v198, v199
    v_lshlrev_b32 v198, 16, v206
    v_and_b32 v199, 0xffff0000, v206
    v_mul_f32 v198, v198, v203
    v_mul_f32 v199, v199, v203
    v_cvt_pk_bf16_f32 v191, v198, v199
    s_mov_b64 exec, s[64:65]
    ds_write_b128 v28, v[184:187] offset:1024
    ds_write_b128 v28, v[188:191] offset:1040
    s_mov_b64 exec, -1
    s_waitcnt lgkmcnt(0)
    ds_read_b128 v[128:131], v30 offset:1024
    ds_read_b128 v[132:135], v30 offset:1088
    ds_read_b128 v[136:139], v30 offset:1152
    ds_read_b128 v[140:143], v30 offset:1216
    ds_read_b128 v[144:147], v30 offset:1280
    ds_read_b128 v[148:151], v30 offset:1344
    ds_read_b128 v[152:155], v30 offset:1408
    ds_read_b128 v[156:159], v30 offset:1472
    ds_read_b128 v[160:163], v30 offset:1536
    ds_read_b128 v[164:167], v30 offset:1600
    ds_read_b128 v[168:171], v30 offset:1664
    ds_read_b128 v[172:175], v30 offset:1728
    ds_read_b128 v[176:179], v30 offset:1792
    ds_read_b128 v[180:183], v30 offset:1856
    s_mul_i32 s55, s68, 0x9e3779b1
    s_add_u32 s55, s55, 0x7f4a7c15
    v_mov_b32 v249, s55
    v_and_b32 v13, 1, v1
    v_lshlrev_b32 v14, 14, v13
    v_cmp_eq_u32 vcc, 1, v13
    v_lshrrev_b32 v13, 1, v1
    v_lshl_add_u32 v14, v13, 3, v14
    s_lshl_b32 s60, s96, 2
    s_add_u32 s60, s60, s52
    s_lshl_b32 s60, s60, 6
    s_add_u32 s60, s60, 16384
    buffer_load_dwordx4 v[64:67], v2, s[28:31], s57 offen offset:0 nt
    buffer_load_dwordx4 v[68:71], v2, s[28:31], s57 offen offset:128 nt
    buffer_load_dwordx4 v[72:75], v2, s[28:31], s57 offen offset:256 nt
    buffer_load_dwordx4 v[76:79], v2, s[28:31], s57 offen offset:384 nt
    buffer_load_dwordx4 v[80:83], v3, s[28:31], s57 offen offset:0 nt
    buffer_load_dwordx4 v[84:87], v3, s[28:31], s57 offen offset:128 nt
    buffer_load_dwordx4 v[88:91], v3, s[28:31], s57 offen offset:256 nt
    buffer_load_dwordx4 v[92:95], v3, s[28:31], s57 offen offset:384 nt
    s_waitcnt vmcnt(8)
    s_barrier
.Lqgo:
    ds_read_b64_tr_b16 v[184:185], v17 offset:0
    ds_read_b64_tr_b16 v[186:187], v17 offset:512
    ds_read_b64_tr_b16 v[188:189], v17 offset:4096
    ds_read_b64_tr_b16 v[190:191], v17 offset:4608
    ds_read_b64_tr_b16 v[192:193], v17 offset:8192
    ds_read_b64_tr_b16 v[194:195], v17 offset:8704
    ds_read_b64_tr_b16 v[196:197], v17 offset:12288
    ds_read_b64_tr_b16 v[198:199], v17 offset:12800
    ds_read_b64_tr_b16 v[200:201], v17 offset:16384
    ds_read_b64_tr_b16 v[202:203], v17 offset:16896
    ds_read_b64_tr_b16 v[204:205], v17 offset:20480
    ds_read_b64_tr_b16 v[206:207], v17 offset:20992
    ds_read_b64_tr_b16 v[208:209], v17 offset:24576
    ds_read_b64_tr_b16 v[210:211], v17 offset:25088
    s_waitcnt lgkmcnt(6)
    ds_read_b64_tr_b16 v[212:213], v17 offset:28672
    ds_read_b64_tr_b16 v[214:215], v17 offset:29184
    ds_read_b64_tr_b16 v[216:217], v17 offset:32768
    ds_read_b64_tr_b16 v[218:219], v17 offset:33280
    ds_read_b64_tr_b16 v[220:221], v17 offset:36864
    ds_read_b64_tr_b16 v[222:223], v17 offset:37376
    ds_read_b64_tr_b16 v[224:225], v17 offset:40960
    ds_read_b64_tr_b16 v[226:227], v17 offset:41472
    ds_read_b64_tr_b16 v[228:229], v17 offset:45056
    ds_read_b64_tr_b16 v[230:231], v17 offset:45568
    ds_read_b64_tr_b16 v[232:233], v17 offset:49152
    ds_read_b64_tr_b16 v[234:235], v17 offset:49664
    ds_read_b64_tr_b16 v[236:237], v17 offset:53248
    ds_read_b64_tr_b16 v[238:239], v17 offset:53760
    s_waitcnt lgkmcnt(0)
    v_mfma_f32_16x16x32_bf16 v[240:243], v[128:131], v[184:187], 0
    v_mfma_f32_16x16x32_bf16 v[240:243], v[132:135], v[188:191], v[240:243]
    v_mfma_f32_16x16x32_bf16 v[240:243], v[136:139], v[192:195], v[240:243]
    v_mfma_f32_16x16x32_bf16 v[240:243], v[140:143], v[196:199], v[240:243]
    v_mfma_f32_16x16x32_bf16 v[240:243], v[144:147], v[200:203], v[240:243]
    v_mfma_f32_16x16x32_bf16 v[240:243], v[148:151], v[204:207], v[240:243]
    v_mfma_f32_16x16x32_bf16 v[240:243], v[152:155], v[208:211], v[240:243]
    v_mfma_f32_16x16x32_bf16 v[240:243], v[156:159], v[212:215], v[240:243]
    v_mfma_f32_16x16x32_bf16 v[240:243], v[160:163], v[216:219], v[240:243]
    v_mfma_f32_16x16x32_bf16 v[240:243], v[164:167], v[220:223], v[240:243]
    v_mfma_f32_16x16x32_bf16 v[240:243], v[168:171], v[224:227], v[240:243]
    v_mfma_f32_16x16x32_bf16 v[240:243], v[172:175], v[228:231], v[240:243]
    v_mfma_f32_16x16x32_bf16 v[240:243], v[176:179], v[232:235], v[240:243]
    v_mfma_f32_16x16x32_bf16 v[240:243], v[180:183], v[236:239], v[240:243]
    s_nop 7
    v_mov_b32_dpp v244, v240 quad_perm:[1,0,3,2] row_mask:0xf bank_mask:0xf
    v_mov_b32_dpp v245, v241 quad_perm:[1,0,3,2] row_mask:0xf bank_mask:0xf
    v_cndmask_b32 v246, v240, v245, vcc
    v_cndmask_b32 v247, v244, v241, vcc
    v_cvt_pk_bf16_f32 v248, v246, v247
    s_mov_b64 exec, 0xffff
    buffer_store_dwordx2 v[248:249], v14, s[36:39], s60 offen sc1
    s_mov_b64 exec, -1
    s_setprio 0
    buffer_load_dwordx4 v[96:99], v4, s[28:31], s57 offen offset:0 nt
    buffer_load_dwordx4 v[100:103], v4, s[28:31], s57 offen offset:128 nt
    buffer_load_dwordx4 v[104:107], v4, s[28:31], s57 offen offset:256 nt
    buffer_load_dwordx4 v[108:111], v4, s[28:31], s57 offen offset:384 nt
    buffer_load_dwordx4 v[112:115], v5, s[28:31], s57 offen offset:0 nt
    buffer_load_dwordx4 v[116:119], v5, s[28:31], s57 offen offset:128 nt
    buffer_load_dwordx4 v[120:123], v5, s[28:31], s57 offen offset:256 nt
    buffer_load_dwordx4 v[124:127], v5, s[28:31], s57 offen offset:384 nt
.Ljoin:
    s_cmp_lg_u32 s52, 1
    s_cbranch_scc1 .Lnorace
    s_lshr_b32 s60, s2, 6
    s_lshl_b32 s60, s60, 14
    s_and_b32 s63, s2, 63
    s_lshl_b32 s63, s63, 7
    s_add_u32 s60, s60, s63
    s_bfe_u32 s41, s2, 0x10003
    s_lshl_b32 s63, s41, 13
    s_add_u32 s60, s60, s63
    s_add_u32 s60, s60, 1507328
    s_xor_b32 s63, s60, 0x2000
    s_getreg_b32 s40, hwreg(HW_REG_XCC_ID, 2, 1)
    s_xor_b32 s41, s41, s40
    s_mov_b32 s42, 0x5bd1e995
    s_mov_b32 s43, 0x5bd1e995
    s_waitcnt lgkmcnt(0)
    s_load_dword s42, s[26:27], s60
    s_load_dword s43, s[26:27], s63
    s_waitcnt lgkmcnt(1)
    s_mov_b64 s[44:45], s[42:43]
    s_cmp_eq_u32 s44, 0x5bd1e995
    s_cselect_b32 s44, 1, 0
    s_cmp_eq_u32 s45, 0x5bd1e995
    s_cselect_b32 s45, 1, 0
    s_xor_b32 s41, s41, s44
    s_cselect_b32 s40, 20, 10
    s_lshl_b32 s40, 1, s40
    s_add_u32 s40, s40, 1
    s_cmp_eq_u32 s44, s45
    s_cselect_b32 s40, 1, s40
.Lnorace:
    s_lshl_b32 s60, s54, 10
    s_add_u32 s60, s60, 16384
    v_lshlrev_b32 v13, 4, v1
    s_add_u32 s56, s56, 32
    s_lshr_b32 s57, s56, 1
    s_lshl_b32 s57, s57, 15
    s_add_u32 s57, s57, s61
    s_and_b32 s63, s56, 1
    s_lshl_b32 s63, s63, 12
    s_add_u32 s57, s57, s63
    s_and_b32 s57, s57, 0x7fffff
    s_waitcnt vmcnt(10)
    buffer_load_dwordx4 v[128:131], v2, s[28:31], s57 offen offset:0 nt
    buffer_load_dwordx4 v[132:135], v2, s[28:31], s57 offen offset:128 nt
    buffer_load_dwordx4 v[136:139], v2, s[28:31], s57 offen offset:256 nt
    buffer_load_dwordx4 v[140:143], v2, s[28:31], s57 offen offset:384 nt
    s_waitcnt vmcnt(10)
    buffer_load_dwordx4 v[144:147], v3, s[28:31], s57 offen offset:0 nt
    buffer_load_dwordx4 v[148:151], v3, s[28:31], s57 offen offset:128 nt
    buffer_load_dwordx4 v[152:155], v3, s[28:31], s57 offen offset:256 nt
    buffer_load_dwordx4 v[156:159], v3, s[28:31], s57 offen offset:384 nt
    s_waitcnt vmcnt(10)
    buffer_load_dwordx4 v[160:163], v4, s[28:31], s57 offen offset:0 nt
    buffer_load_dwordx4 v[164:167], v4, s[28:31], s57 offen offset:128 nt
    buffer_load_dwordx4 v[168:171], v4, s[28:31], s57 offen offset:256 nt
    buffer_load_dwordx4 v[172:175], v4, s[28:31], s57 offen offset:384 nt
    s_waitcnt vmcnt(10)
    buffer_load_dwordx4 v[176:179], v5, s[28:31], s57 offen offset:0 nt
    buffer_load_dwordx4 v[180:183], v5, s[28:31], s57 offen offset:128 nt
    buffer_load_dwordx4 v[184:187], v5, s[28:31], s57 offen offset:256 nt
    buffer_load_dwordx4 v[188:191], v5, s[28:31], s57 offen offset:384 nt
    s_add_u32 s56, s56, 32
    s_lshr_b32 s57, s56, 1
    s_lshl_b32 s57, s57, 15
    s_add_u32 s57, s57, s61
    s_and_b32 s63, s56, 1
    s_lshl_b32 s63, s63, 12
    s_add_u32 s57, s57, s63
    s_and_b32 s57, s57, 0x7fffff
    s_waitcnt vmcnt(10)
    buffer_load_dwordx4 v[192:195], v2, s[28:31], s57 offen offset:0 nt
    buffer_load_dwordx4 v[196:199], v2, s[28:31], s57 offen offset:128 nt
    buffer_load_dwordx4 v[200:203], v2, s[28:31], s57 offen offset:256 nt
    buffer_load_dwordx4 v[204:207], v2, s[28:31], s57 offen offset:384 nt
    s_cmp_lg_u32 s52, 0
    s_cbranch_scc1 .Lnp0
    buffer_load_dwordx4 v[48:51], v13, s[36:39], s60 offen sc1
.Lnp0:
    s_waitcnt vmcnt(10)
    buffer_load_dwordx4 v[208:211], v3, s[28:31], s57 offen offset:0 nt
    buffer_load_dwordx4 v[212:215], v3, s[28:31], s57 offen offset:128 nt
    buffer_load_dwordx4 v[216:219], v3, s[28:31], s57 offen offset:256 nt
    buffer_load_dwordx4 v[220:223], v3, s[28:31], s57 offen offset:384 nt
    s_cmp_lg_u32 s52, 0
    s_cbranch_scc1 .Lnp1
    buffer_load_dwordx4 v[52:55], v13, s[36:39], s60 offen sc1
.Lnp1:
    s_waitcnt vmcnt(10)
    buffer_load_dwordx4 v[224:227], v4, s[28:31], s57 offen offset:0 nt
    buffer_load_dwordx4 v[228:231], v4, s[28:31], s57 offen offset:128 nt
    buffer_load_dwordx4 v[232:235], v4, s[28:31], s57 offen offset:256 nt
    buffer_load_dwordx4 v[236:239], v4, s[28:31], s57 offen offset:384 nt
    s_cmp_lg_u32 s52, 0
    s_cbranch_scc1 .Lnp2
    buffer_load_dwordx4 v[56:59], v13, s[36:39], s60 offen sc1
.Lnp2:
    s_waitcnt vmcnt(10)
    buffer_load_dwordx4 v[240:243], v5, s[28:31], s57 offen offset:0 nt
    buffer_load_dwordx4 v[244:247], v5, s[28:31], s57 offen offset:128 nt
    buffer_load_dwordx4 v[248:251], v5, s[28:31], s57 offen offset:256 nt
    buffer_load_dwordx4 v[252:255], v5, s[28:31], s57 offen offset:384 nt
    s_cmp_lg_u32 s52, 0
    s_cbranch_scc1 .Lnp3
    buffer_load_dwordx4 v[60:63], v13, s[36:39], s60 offen sc1
.Lnp3:
    s_cmp_eq_u32 s52, 0
    s_cbranch_scc1 .Lw0
    s_mov_b32 s99, 3
    s_mov_b32 s97, 2
    s_mov_b32 s101, 16
    s_mov_b32 s62, 4
    s_branch .Lbar
.Lw0:
    s_lshl_b32 s60, s54, 10
    s_add_u32 s60, s60, 16384
    v_lshlrev_b32 v13, 4, v1
    v_lshlrev_b32 v14, 3, v1
    ds_write_b32 v15, v15 offset:520
    ds_write_b32 v15, v15 offset:528
    ds_write_b32 v15, v15 offset:532
    ds_write_b32 v15, v15 offset:536
    s_waitcnt lgkmcnt(0)
    s_mul_i32 s55, s68, 0x9e3779b1
    s_add_u32 s55, s55, 0x7f4a7c15
    s_waitcnt vmcnt(15)
    v_cmp_ne_u32 vcc, s55, v49
    v_cmp_ne_u32 s[66:67], s55, v51
    s_or_b64 vcc, vcc, s[66:67]
    s_cbranch_vccz .Lqok0
    buffer_load_dwordx4 v[48:51], v13, s[36:39], s60 offen sc1
    s_waitcnt vmcnt(11)
    v_cmp_ne_u32 vcc, s55, v53
    v_cmp_ne_u32 s[66:67], s55, v55
    s_or_b64 vcc, vcc, s[66:67]
    s_cbranch_vccz .Lqok1
    buffer_load_dwordx4 v[52:55], v13, s[36:39], s60 offen sc1
    s_waitcnt vmcnt(7)
    v_cmp_ne_u32 vcc, s55, v57
    v_cmp_ne_u32 s[66:67], s55, v59
    s_or_b64 vcc, vcc, s[66:67]
    s_cbranch_vccz .Lqok2
    buffer_load_dwordx4 v[56:59], v13, s[36:39], s60 offen sc1
    s_waitcnt vmcnt(3)
    v_cmp_ne_u32 vcc, s55, v61
    v_cmp_ne_u32 s[66:67], s55, v63
    s_or_b64 vcc, vcc, s[66:67]
    s_cbranch_vccz .Lqok3
    buffer_load_dwordx4 v[60:63], v13, s[36:39], s60 offen sc1
    s_mov_b32 s62, 20000
.Lqpoll:
    s_waitcnt vmcnt(3)
    v_cmp_ne_u32 vcc, s55, v49
    v_cmp_ne_u32 s[66:67], s55, v51
    s_or_b64 vcc, vcc, s[66:67]
    s_cbranch_vccz .Lqok0
    buffer_load_dwordx4 v[48:51], v13, s[36:39], s60 offen sc1
    s_waitcnt vmcnt(3)
    v_cmp_ne_u32 vcc, s55, v53
    v_cmp_ne_u32 s[66:67], s55, v55
    s_or_b64 vcc, vcc, s[66:67]
    s_cbranch_vccz .Lqok1
    buffer_load_dwordx4 v[52:55], v13, s[36:39], s60 offen sc1
    s_waitcnt vmcnt(3)
    v_cmp_ne_u32 vcc, s55, v57
    v_cmp_ne_u32 s[66:67], s55, v59
    s_or_b64 vcc, vcc, s[66:67]
    s_cbranch_vccz .Lqok2
    buffer_load_dwordx4 v[56:59], v13, s[36:39], s60 offen sc1
    s_waitcnt vmcnt(3)
    v_cmp_ne_u32 vcc, s55, v61
    v_cmp_ne_u32 s[66:67], s55, v63
    s_or_b64 vcc, vcc, s[66:67]
    s_cbranch_vccz .Lqok3
    buffer_load_dwordx4 v[60:63], v13, s[36:39], s60 offen sc1
    s_sub_u32 s62, s62, 1
    s_cmp_lg_u32 s62, 0
    s_cbranch_scc1 .Lqpoll
.Lqok0:
    ds_write2_b32 v14, v48, v50 offset0:0 offset1:1
    s_branch .Lqok
.Lqok1:
    ds_write2_b32 v14, v52, v54 offset0:0 offset1:1
    s_branch .Lqok
.Lqok2:
    ds_write2_b32 v14, v56, v58 offset0:0 offset1:1
    s_branch .Lqok
.Lqok3:
    ds_write2_b32 v14, v60, v62 offset0:0 offset1:1
.Lqok:
    s_mov_b32 s99, 3
    s_mov_b32 s97, 2
    s_mov_b32 s101, 16
    s_mov_b32 s62, 4
    s_waitcnt lgkmcnt(0)
.Lbar:
    s_barrier
    v_and_b32 v13, 7, v1
    v_lshlrev_b32 v13, 4, v13
    ds_read_b128 v[32:35], v13 offset:0
    ds_read_b128 v[36:39], v13 offset:128
    ds_read_b128 v[40:43], v13 offset:256
    ds_read_b128 v[44:47], v13 offset:384
    v_readlane_b32 s56, v23, s99
    s_lshr_b32 s57, s56, 1
    s_lshl_b32 s57, s57, 15
    s_add_u32 s57, s57, s61
    s_and_b32 s63, s56, 1
    s_lshl_b32 s63, s63, 12
    s_add_u32 s57, s57, s63
    s_and_b32 s57, s57, 0x7fffff
    s_waitcnt lgkmcnt(0)
    s_mul_i32 s55, s68, 0x9e3779b1
    s_add_u32 s55, s55, 0x7f4a7c15
    v_mov_b32 v23, 0xff800000
    v_mov_b32 v11, 0
    v_mov_b32 v12, 0
    v_mov_b32 v13, 0
    v_mov_b32 v14, 0
    v_mov_b32 v15, 0
    v_mov_b32 v16, 0
    v_mov_b32 v17, 0
    v_mov_b32 v18, 0
    s_waitcnt vmcnt(44)
    v_dot2c_f32_bf16 v11, v64, v32
    v_dot2c_f32_bf16 v12, v65, v33
    v_dot2c_f32_bf16 v11, v66, v34
    v_dot2c_f32_bf16 v12, v67, v35
    s_waitcnt vmcnt(7)
    buffer_load_dwordx4 v[64:67], v2, s[28:31], s57 offen offset:0 nt
    v_dot2c_f32_bf16 v11, v68, v36
    v_dot2c_f32_bf16 v12, v69, v37
    v_dot2c_f32_bf16 v11, v70, v38
    v_dot2c_f32_bf16 v12, v71, v39
    s_waitcnt vmcnt(7)
    buffer_load_dwordx4 v[68:71], v2, s[28:31], s57 offen offset:128 nt
    v_dot2c_f32_bf16 v11, v72, v40
    v_dot2c_f32_bf16 v12, v73, v41
    v_dot2c_f32_bf16 v11, v74, v42
    v_dot2c_f32_bf16 v12, v75, v43
    s_waitcnt vmcnt(7)
    buffer_load_dwordx4 v[72:75], v2, s[28:31], s57 offen offset:256 nt
    v_dot2c_f32_bf16 v11, v76, v44
    v_dot2c_f32_bf16 v12, v77, v45
    v_dot2c_f32_bf16 v11, v78, v46
    v_dot2c_f32_bf16 v12, v79, v47
    s_waitcnt vmcnt(7)
    buffer_load_dwordx4 v[76:79], v2, s[28:31], s57 offen offset:384 nt
    s_waitcnt vmcnt(44)
    v_dot2c_f32_bf16 v13, v80, v32
    v_dot2c_f32_bf16 v14, v81, v33
    v_dot2c_f32_bf16 v13, v82, v34
    v_dot2c_f32_bf16 v14, v83, v35
    s_waitcnt vmcnt(7)
    buffer_load_dwordx4 v[80:83], v3, s[28:31], s57 offen offset:0 nt
    v_dot2c_f32_bf16 v13, v84, v36
    v_dot2c_f32_bf16 v14, v85, v37
    v_dot2c_f32_bf16 v13, v86, v38
    v_dot2c_f32_bf16 v14, v87, v39
    s_waitcnt vmcnt(7)
    buffer_load_dwordx4 v[84:87], v3, s[28:31], s57 offen offset:128 nt
    v_dot2c_f32_bf16 v13, v88, v40
    v_dot2c_f32_bf16 v14, v89, v41
    v_dot2c_f32_bf16 v13, v90, v42
    v_dot2c_f32_bf16 v14, v91, v43
    s_waitcnt vmcnt(7)
    buffer_load_dwordx4 v[88:91], v3, s[28:31], s57 offen offset:256 nt
    v_dot2c_f32_bf16 v13, v92, v44
    v_dot2c_f32_bf16 v14, v93, v45
    v_dot2c_f32_bf16 v13, v94, v46
    v_dot2c_f32_bf16 v14, v95, v47
    s_waitcnt vmcnt(7)
    buffer_load_dwordx4 v[92:95], v3, s[28:31], s57 offen offset:384 nt
    s_waitcnt vmcnt(44)
    v_dot2c_f32_bf16 v15, v96, v32
    v_dot2c_f32_bf16 v16, v97, v33
    v_dot2c_f32_bf16 v15, v98, v34
    v_dot2c_f32_bf16 v16, v99, v35
    s_waitcnt vmcnt(7)
    buffer_load_dwordx4 v[96:99], v4, s[28:31], s57 offen offset:0 nt
    v_dot2c_f32_bf16 v15, v100, v36
    v_dot2c_f32_bf16 v16, v101, v37
    v_dot2c_f32_bf16 v15, v102, v38
    v_dot2c_f32_bf16 v16, v103, v39
    s_waitcnt vmcnt(7)
    buffer_load_dwordx4 v[100:103], v4, s[28:31], s57 offen offset:128 nt
    v_dot2c_f32_bf16 v15, v104, v40
    v_dot2c_f32_bf16 v16, v105, v41
    v_dot2c_f32_bf16 v15, v106, v42
    v_dot2c_f32_bf16 v16, v107, v43
    s_waitcnt vmcnt(7)
    buffer_load_dwordx4 v[104:107], v4, s[28:31], s57 offen offset:256 nt
    v_dot2c_f32_bf16 v15, v108, v44
    v_dot2c_f32_bf16 v16, v109, v45
    v_dot2c_f32_bf16 v15, v110, v46
    v_dot2c_f32_bf16 v16, v111, v47
    s_waitcnt vmcnt(7)
    buffer_load_dwordx4 v[108:111], v4, s[28:31], s57 offen offset:384 nt
    s_waitcnt vmcnt(44)
    v_dot2c_f32_bf16 v17, v112, v32
    v_dot2c_f32_bf16 v18, v113, v33
    v_dot2c_f32_bf16 v17, v114, v34
    v_dot2c_f32_bf16 v18, v115, v35
    s_waitcnt vmcnt(7)
    buffer_load_dwordx4 v[112:115], v5, s[28:31], s57 offen offset:0 nt
    v_dot2c_f32_bf16 v17, v116, v36
    v_dot2c_f32_bf16 v18, v117, v37
    v_dot2c_f32_bf16 v17, v118, v38
    v_dot2c_f32_bf16 v18, v119, v39
    s_waitcnt vmcnt(7)
    buffer_load_dwordx4 v[116:119], v5, s[28:31], s57 offen offset:128 nt
    v_dot2c_f32_bf16 v17, v120, v40
    v_dot2c_f32_bf16 v18, v121, v41
    v_dot2c_f32_bf16 v17, v122, v42
    v_dot2c_f32_bf16 v18, v123, v43
    s_waitcnt vmcnt(7)
    buffer_load_dwordx4 v[120:123], v5, s[28:31], s57 offen offset:256 nt
    v_dot2c_f32_bf16 v17, v124, v44
    v_dot2c_f32_bf16 v18, v125, v45
    v_dot2c_f32_bf16 v17, v126, v46
    v_dot2c_f32_bf16 v18, v127, v47
    s_waitcnt vmcnt(7)
    buffer_load_dwordx4 v[124:127], v5, s[28:31], s57 offen offset:384 nt
    v_add_f32 v11, v11, v12
    v_add_f32 v13, v13, v14
    v_add_f32 v15, v15, v16
    v_add_f32 v17, v17, v18
    v_add_f32_dpp v11, v11, v11 quad_perm:[1,0,3,2] row_mask:0xf bank_mask:0xf
    v_add_f32_dpp v13, v13, v13 quad_perm:[1,0,3,2] row_mask:0xf bank_mask:0xf
    v_add_f32_dpp v15, v15, v15 quad_perm:[1,0,3,2] row_mask:0xf bank_mask:0xf
    v_add_f32_dpp v17, v17, v17 quad_perm:[1,0,3,2] row_mask:0xf bank_mask:0xf
    v_add_f32_dpp v11, v11, v11 quad_perm:[2,3,0,1] row_mask:0xf bank_mask:0xf
    v_add_f32_dpp v13, v13, v13 quad_perm:[2,3,0,1] row_mask:0xf bank_mask:0xf
    v_add_f32_dpp v15, v15, v15 quad_perm:[2,3,0,1] row_mask:0xf bank_mask:0xf
    v_add_f32_dpp v17, v17, v17 quad_perm:[2,3,0,1] row_mask:0xf bank_mask:0xf
    v_add_f32_dpp v11, v11, v11 row_half_mirror row_mask:0xf bank_mask:0xf
    v_add_f32_dpp v13, v13, v13 row_half_mirror row_mask:0xf bank_mask:0xf
    v_add_f32_dpp v15, v15, v15 row_half_mirror row_mask:0xf bank_mask:0xf
    v_add_f32_dpp v17, v17, v17 row_half_mirror row_mask:0xf bank_mask:0xf
    v_cvt_pk_bf16_f32 v24, v11, v13
    v_cvt_pk_bf16_f32 v25, v15, v17
    ds_write_b64 v19, v[24:25]
    v_add_u32 v19, 64, v19
    v_max3_f32 v23, v23, v11, v13
    v_max3_f32 v23, v23, v15, v17
    v_mov_b32 v11, 0
    v_mov_b32 v12, 0
    v_mov_b32 v13, 0
    v_mov_b32 v14, 0
    v_mov_b32 v15, 0
    v_mov_b32 v16, 0
    v_mov_b32 v17, 0
    v_mov_b32 v18, 0
    s_waitcnt vmcnt(44)
    v_dot2c_f32_bf16 v11, v128, v32
    v_dot2c_f32_bf16 v12, v129, v33
    v_dot2c_f32_bf16 v11, v130, v34
    v_dot2c_f32_bf16 v12, v131, v35
    v_dot2c_f32_bf16 v11, v132, v36
    v_dot2c_f32_bf16 v12, v133, v37
    v_dot2c_f32_bf16 v11, v134, v38
    v_dot2c_f32_bf16 v12, v135, v39
    v_dot2c_f32_bf16 v11, v136, v40
    v_dot2c_f32_bf16 v12, v137, v41
    v_dot2c_f32_bf16 v11, v138, v42
    v_dot2c_f32_bf16 v12, v139, v43
    v_dot2c_f32_bf16 v11, v140, v44
    v_dot2c_f32_bf16 v12, v141, v45
    v_dot2c_f32_bf16 v11, v142, v46
    v_dot2c_f32_bf16 v12, v143, v47
    s_waitcnt vmcnt(40)
    v_dot2c_f32_bf16 v13, v144, v32
    v_dot2c_f32_bf16 v14, v145, v33
    v_dot2c_f32_bf16 v13, v146, v34
    v_dot2c_f32_bf16 v14, v147, v35
    v_dot2c_f32_bf16 v13, v148, v36
    v_dot2c_f32_bf16 v14, v149, v37
    v_dot2c_f32_bf16 v13, v150, v38
    v_dot2c_f32_bf16 v14, v151, v39
    v_dot2c_f32_bf16 v13, v152, v40
    v_dot2c_f32_bf16 v14, v153, v41
    v_dot2c_f32_bf16 v13, v154, v42
    v_dot2c_f32_bf16 v14, v155, v43
    v_dot2c_f32_bf16 v13, v156, v44
    v_dot2c_f32_bf16 v14, v157, v45
    v_dot2c_f32_bf16 v13, v158, v46
    v_dot2c_f32_bf16 v14, v159, v47
    s_waitcnt vmcnt(36)
    v_dot2c_f32_bf16 v15, v160, v32
    v_dot2c_f32_bf16 v16, v161, v33
    v_dot2c_f32_bf16 v15, v162, v34
    v_dot2c_f32_bf16 v16, v163, v35
    v_dot2c_f32_bf16 v15, v164, v36
    v_dot2c_f32_bf16 v16, v165, v37
    v_dot2c_f32_bf16 v15, v166, v38
    v_dot2c_f32_bf16 v16, v167, v39
    v_dot2c_f32_bf16 v15, v168, v40
    v_dot2c_f32_bf16 v16, v169, v41
    v_dot2c_f32_bf16 v15, v170, v42
    v_dot2c_f32_bf16 v16, v171, v43
    v_dot2c_f32_bf16 v15, v172, v44
    v_dot2c_f32_bf16 v16, v173, v45
    v_dot2c_f32_bf16 v15, v174, v46
    v_dot2c_f32_bf16 v16, v175, v47
    s_waitcnt vmcnt(32)
    v_dot2c_f32_bf16 v17, v176, v32
    v_dot2c_f32_bf16 v18, v177, v33
    v_dot2c_f32_bf16 v17, v178, v34
    v_dot2c_f32_bf16 v18, v179, v35
    v_dot2c_f32_bf16 v17, v180, v36
    v_dot2c_f32_bf16 v18, v181, v37
    v_dot2c_f32_bf16 v17, v182, v38
    v_dot2c_f32_bf16 v18, v183, v39
    v_dot2c_f32_bf16 v17, v184, v40
    v_dot2c_f32_bf16 v18, v185, v41
    v_dot2c_f32_bf16 v17, v186, v42
    v_dot2c_f32_bf16 v18, v187, v43
    v_dot2c_f32_bf16 v17, v188, v44
    v_dot2c_f32_bf16 v18, v189, v45
    v_dot2c_f32_bf16 v17, v190, v46
    v_dot2c_f32_bf16 v18, v191, v47
    s_nop 2
    v_add_f32 v11, v11, v12
    v_add_f32 v13, v13, v14
    v_add_f32 v15, v15, v16
    v_add_f32 v17, v17, v18
    v_add_f32_dpp v11, v11, v11 quad_perm:[1,0,3,2] row_mask:0xf bank_mask:0xf
    v_add_f32_dpp v13, v13, v13 quad_perm:[1,0,3,2] row_mask:0xf bank_mask:0xf
    v_add_f32_dpp v15, v15, v15 quad_perm:[1,0,3,2] row_mask:0xf bank_mask:0xf
    v_add_f32_dpp v17, v17, v17 quad_perm:[1,0,3,2] row_mask:0xf bank_mask:0xf
    v_add_f32_dpp v11, v11, v11 quad_perm:[2,3,0,1] row_mask:0xf bank_mask:0xf
    v_add_f32_dpp v13, v13, v13 quad_perm:[2,3,0,1] row_mask:0xf bank_mask:0xf
    v_add_f32_dpp v15, v15, v15 quad_perm:[2,3,0,1] row_mask:0xf bank_mask:0xf
    v_add_f32_dpp v17, v17, v17 quad_perm:[2,3,0,1] row_mask:0xf bank_mask:0xf
    v_add_f32_dpp v11, v11, v11 row_half_mirror row_mask:0xf bank_mask:0xf
    v_add_f32_dpp v13, v13, v13 row_half_mirror row_mask:0xf bank_mask:0xf
    v_add_f32_dpp v15, v15, v15 row_half_mirror row_mask:0xf bank_mask:0xf
    v_add_f32_dpp v17, v17, v17 row_half_mirror row_mask:0xf bank_mask:0xf
    v_cvt_pk_bf16_f32 v24, v11, v13
    v_cvt_pk_bf16_f32 v25, v15, v17
    ds_write_b64 v19, v[24:25]
    v_add_u32 v19, 64, v19
    v_max3_f32 v23, v23, v11, v13
    v_max3_f32 v23, v23, v15, v17
    s_cmp_lg_u32 s52, 1
    s_cbranch_scc1 .Lnoreset
    v_mov_b32 v24, -1
    v_mov_b32 v25, -1
    v_mov_b32 v26, -1
    v_mov_b32 v27, -1
    v_lshlrev_b32 v18, 4, v1
    s_and_b32 s63, s2, 0x87
    s_cmp_eq_u32 s63, 0x87
    s_cbranch_scc1 .Lnoreset
    s_mov_b64 s[36:37], s[26:27]
    s_lshl_b32 s63, s2, 10
    s_add_u32 s63, s63, 1048576
    s_cmp_ge_u32 s2, 192
    s_cbranch_scc1 .Lnoreset
    buffer_store_dwordx4 v[24:27], v18, s[36:39], s63 offen sc1
    s_add_u32 s63, s63, 0x40000
.Lnoreset:
    v_mov_b32 v11, 0
    v_mov_b32 v12, 0
    v_mov_b32 v13, 0
    v_mov_b32 v14, 0
    v_mov_b32 v15, 0
    v_mov_b32 v16, 0
    v_mov_b32 v17, 0
    v_mov_b32 v18, 0
    s_waitcnt vmcnt(28)
    v_dot2c_f32_bf16 v11, v192, v32
    v_dot2c_f32_bf16 v12, v193, v33
    v_dot2c_f32_bf16 v11, v194, v34
    v_dot2c_f32_bf16 v12, v195, v35
    v_dot2c_f32_bf16 v11, v196, v36
    v_dot2c_f32_bf16 v12, v197, v37
    v_dot2c_f32_bf16 v11, v198, v38
    v_dot2c_f32_bf16 v12, v199, v39
    v_dot2c_f32_bf16 v11, v200, v40
    v_dot2c_f32_bf16 v12, v201, v41
    v_dot2c_f32_bf16 v11, v202, v42
    v_dot2c_f32_bf16 v12, v203, v43
    v_dot2c_f32_bf16 v11, v204, v44
    v_dot2c_f32_bf16 v12, v205, v45
    v_dot2c_f32_bf16 v11, v206, v46
    v_dot2c_f32_bf16 v12, v207, v47
    s_waitcnt vmcnt(24)
    v_dot2c_f32_bf16 v13, v208, v32
    v_dot2c_f32_bf16 v14, v209, v33
    v_dot2c_f32_bf16 v13, v210, v34
    v_dot2c_f32_bf16 v14, v211, v35
    v_dot2c_f32_bf16 v13, v212, v36
    v_dot2c_f32_bf16 v14, v213, v37
    v_dot2c_f32_bf16 v13, v214, v38
    v_dot2c_f32_bf16 v14, v215, v39
    v_dot2c_f32_bf16 v13, v216, v40
    v_dot2c_f32_bf16 v14, v217, v41
    v_dot2c_f32_bf16 v13, v218, v42
    v_dot2c_f32_bf16 v14, v219, v43
    v_dot2c_f32_bf16 v13, v220, v44
    v_dot2c_f32_bf16 v14, v221, v45
    v_dot2c_f32_bf16 v13, v222, v46
    v_dot2c_f32_bf16 v14, v223, v47
    s_waitcnt vmcnt(20)
    v_dot2c_f32_bf16 v15, v224, v32
    v_dot2c_f32_bf16 v16, v225, v33
    v_dot2c_f32_bf16 v15, v226, v34
    v_dot2c_f32_bf16 v16, v227, v35
    v_dot2c_f32_bf16 v15, v228, v36
    v_dot2c_f32_bf16 v16, v229, v37
    v_dot2c_f32_bf16 v15, v230, v38
    v_dot2c_f32_bf16 v16, v231, v39
    v_dot2c_f32_bf16 v15, v232, v40
    v_dot2c_f32_bf16 v16, v233, v41
    v_dot2c_f32_bf16 v15, v234, v42
    v_dot2c_f32_bf16 v16, v235, v43
    v_dot2c_f32_bf16 v15, v236, v44
    v_dot2c_f32_bf16 v16, v237, v45
    v_dot2c_f32_bf16 v15, v238, v46
    v_dot2c_f32_bf16 v16, v239, v47
    s_waitcnt vmcnt(16)
    v_dot2c_f32_bf16 v17, v240, v32
    v_dot2c_f32_bf16 v18, v241, v33
    v_dot2c_f32_bf16 v17, v242, v34
    v_dot2c_f32_bf16 v18, v243, v35
    v_dot2c_f32_bf16 v17, v244, v36
    v_dot2c_f32_bf16 v18, v245, v37
    v_dot2c_f32_bf16 v17, v246, v38
    v_dot2c_f32_bf16 v18, v247, v39
    v_dot2c_f32_bf16 v17, v248, v40
    v_dot2c_f32_bf16 v18, v249, v41
    v_dot2c_f32_bf16 v17, v250, v42
    v_dot2c_f32_bf16 v18, v251, v43
    v_dot2c_f32_bf16 v17, v252, v44
    v_dot2c_f32_bf16 v18, v253, v45
    v_dot2c_f32_bf16 v17, v254, v46
    v_dot2c_f32_bf16 v18, v255, v47
    v_add_f32 v11, v11, v12
    v_add_f32 v13, v13, v14
    v_add_f32 v15, v15, v16
    v_add_f32_dpp v11, v11, v11 quad_perm:[1,0,3,2] row_mask:0xf bank_mask:0xf
    v_add_f32_dpp v13, v13, v13 quad_perm:[1,0,3,2] row_mask:0xf bank_mask:0xf
    v_add_f32_dpp v15, v15, v15 quad_perm:[1,0,3,2] row_mask:0xf bank_mask:0xf
    v_add_f32_dpp v11, v11, v11 quad_perm:[2,3,0,1] row_mask:0xf bank_mask:0xf
    v_add_f32_dpp v13, v13, v13 quad_perm:[2,3,0,1] row_mask:0xf bank_mask:0xf
    v_add_f32_dpp v15, v15, v15 quad_perm:[2,3,0,1] row_mask:0xf bank_mask:0xf
    v_add_f32_dpp v11, v11, v11 row_half_mirror row_mask:0xf bank_mask:0xf
    v_add_f32_dpp v13, v13, v13 row_half_mirror row_mask:0xf bank_mask:0xf
    v_add_f32_dpp v15, v15, v15 row_half_mirror row_mask:0xf bank_mask:0xf
    v_subrev_u32 v206, 128, v19
    v_cvt_pk_bf16_f32 v24, v11, v13
    v_max3_f32 v23, v23, v11, v13
    v_mov_b32 v11, 0
    v_mov_b32 v12, 0
    v_mov_b32 v13, 0
    v_mov_b32 v14, 0
    v_mov_b32 v16, 0
    s_xor_b32 s69, s53, s54
    s_and_b32 s69, s69, 3
    s_cselect_b32 s69, 1, 3
    s_sub_u32 s99, 12, s69
    s_waitcnt vmcnt(15)
.Lkw:
    s_add_u32 s57, s57, 0x80000
    s_and_b32 s57, s57, 0x7fffff
    v_dot2c_f32_bf16 v11, v64, v32
    v_dot2c_f32_bf16 v12, v65, v33
    v_dot2c_f32_bf16 v11, v66, v34
    v_dot2c_f32_bf16 v12, v67, v35
    v_add_f32 v17, v17, v18
    s_waitcnt vmcnt(7)
    buffer_load_dwordx4 v[64:67], v2, s[28:31], s57 offen offset:0 nt
    v_dot2c_f32_bf16 v11, v68, v36
    v_dot2c_f32_bf16 v12, v69, v37
    v_dot2c_f32_bf16 v11, v70, v38
    v_dot2c_f32_bf16 v12, v71, v39
    v_add_f32_dpp v17, v17, v17 quad_perm:[1,0,3,2] row_mask:0xf bank_mask:0xf
    v_mov_b32 v18, 0
    s_waitcnt vmcnt(7)
    buffer_load_dwordx4 v[68:71], v2, s[28:31], s57 offen offset:128 nt
    v_dot2c_f32_bf16 v11, v72, v40
    v_dot2c_f32_bf16 v12, v73, v41
    v_dot2c_f32_bf16 v11, v74, v42
    v_dot2c_f32_bf16 v12, v75, v43
    v_add_f32_dpp v17, v17, v17 quad_perm:[2,3,0,1] row_mask:0xf bank_mask:0xf
    s_waitcnt vmcnt(7)
    buffer_load_dwordx4 v[72:75], v2, s[28:31], s57 offen offset:256 nt
    v_dot2c_f32_bf16 v11, v76, v44
    v_dot2c_f32_bf16 v12, v77, v45
    v_dot2c_f32_bf16 v11, v78, v46
    v_dot2c_f32_bf16 v12, v79, v47
    v_add_f32_dpp v17, v17, v17 row_half_mirror row_mask:0xf bank_mask:0xf
    s_waitcnt vmcnt(7)
    buffer_load_dwordx4 v[76:79], v2, s[28:31], s57 offen offset:384 nt
    v_dot2c_f32_bf16 v13, v80, v32
    v_dot2c_f32_bf16 v14, v81, v33
    v_dot2c_f32_bf16 v13, v82, v34
    v_dot2c_f32_bf16 v14, v83, v35
    v_add_f32 v11, v11, v12
    v_cvt_pk_bf16_f32 v25, v15, v17
    v_max3_f32 v23, v23, v15, v17
    s_waitcnt vmcnt(7)
    buffer_load_dwordx4 v[80:83], v3, s[28:31], s57 offen offset:0 nt
    v_dot2c_f32_bf16 v13, v84, v36
    v_dot2c_f32_bf16 v14, v85, v37
    v_dot2c_f32_bf16 v13, v86, v38
    v_dot2c_f32_bf16 v14, v87, v39
    v_add_f32_dpp v11, v11, v11 quad_perm:[1,0,3,2] row_mask:0xf bank_mask:0xf
    v_mov_b32 v12, 0
    ds_write_b64 v19, v[24:25]
    v_add_u32 v19, 64, v19
    v_mov_b32 v15, 0
    v_mov_b32 v17, 0
    s_waitcnt vmcnt(7)
    buffer_load_dwordx4 v[84:87], v3, s[28:31], s57 offen offset:128 nt
    v_dot2c_f32_bf16 v13, v88, v40
    v_dot2c_f32_bf16 v14, v89, v41
    v_dot2c_f32_bf16 v13, v90, v42
    v_dot2c_f32_bf16 v14, v91, v43
    v_add_f32_dpp v11, v11, v11 quad_perm:[2,3,0,1] row_mask:0xf bank_mask:0xf
    s_waitcnt vmcnt(7)
    buffer_load_dwordx4 v[88:91], v3, s[28:31], s57 offen offset:256 nt
    v_dot2c_f32_bf16 v13, v92, v44
    v_dot2c_f32_bf16 v14, v93, v45
    v_dot2c_f32_bf16 v13, v94, v46
    v_dot2c_f32_bf16 v14, v95, v47
    v_add_f32_dpp v11, v11, v11 row_half_mirror row_mask:0xf bank_mask:0xf
    s_waitcnt vmcnt(7)
    buffer_load_dwordx4 v[92:95], v3, s[28:31], s57 offen offset:384 nt
    v_dot2c_f32_bf16 v15, v96, v32
    v_dot2c_f32_bf16 v16, v97, v33
    v_dot2c_f32_bf16 v15, v98, v34
    v_dot2c_f32_bf16 v16, v99, v35
    v_add_f32 v13, v13, v14
    s_waitcnt vmcnt(7)
    buffer_load_dwordx4 v[96:99], v4, s[28:31], s57 offen offset:0 nt
    v_dot2c_f32_bf16 v15, v100, v36
    v_dot2c_f32_bf16 v16, v101, v37
    v_dot2c_f32_bf16 v15, v102, v38
    v_dot2c_f32_bf16 v16, v103, v39
    v_add_f32_dpp v13, v13, v13 quad_perm:[1,0,3,2] row_mask:0xf bank_mask:0xf
    v_mov_b32 v14, 0
    s_waitcnt vmcnt(7)
    buffer_load_dwordx4 v[100:103], v4, s[28:31], s57 offen offset:128 nt
    v_dot2c_f32_bf16 v15, v104, v40
    v_dot2c_f32_bf16 v16, v105, v41
    v_dot2c_f32_bf16 v15, v106, v42
    v_dot2c_f32_bf16 v16, v107, v43
    v_add_f32_dpp v13, v13, v13 quad_perm:[2,3,0,1] row_mask:0xf bank_mask:0xf
    s_waitcnt vmcnt(7)
    buffer_load_dwordx4 v[104:107], v4, s[28:31], s57 offen offset:256 nt
    v_dot2c_f32_bf16 v15, v108, v44
    v_dot2c_f32_bf16 v16, v109, v45
    v_dot2c_f32_bf16 v15, v110, v46
    v_dot2c_f32_bf16 v16, v111, v47
    v_add_f32_dpp v13, v13, v13 row_half_mirror row_mask:0xf bank_mask:0xf
    s_waitcnt vmcnt(7)
    buffer_load_dwordx4 v[108:111], v4, s[28:31], s57 offen offset:384 nt
    v_dot2c_f32_bf16 v17, v112, v32
    v_dot2c_f32_bf16 v18, v113, v33
    v_dot2c_f32_bf16 v17, v114, v34
    v_dot2c_f32_bf16 v18, v115, v35
    v_add_f32 v15, v15, v16
    v_cvt_pk_bf16_f32 v24, v11, v13
    v_max3_f32 v23, v23, v11, v13
    s_waitcnt vmcnt(7)
    buffer_load_dwordx4 v[112:115], v5, s[28:31], s57 offen offset:0 nt
    v_dot2c_f32_bf16 v17, v116, v36
    v_dot2c_f32_bf16 v18, v117, v37
    v_dot2c_f32_bf16 v17, v118, v38
    v_dot2c_f32_bf16 v18, v119, v39
    v_add_f32_dpp v15, v15, v15 quad_perm:[1,0,3,2] row_mask:0xf bank_mask:0xf
    v_mov_b32 v16, 0
    v_mov_b32 v11, 0
    v_mov_b32 v13, 0
    s_waitcnt vmcnt(7)
    buffer_load_dwordx4 v[116:119], v5, s[28:31], s57 offen offset:128 nt
    v_dot2c_f32_bf16 v17, v120, v40
    v_dot2c_f32_bf16 v18, v121, v41
    v_dot2c_f32_bf16 v17, v122, v42
    v_dot2c_f32_bf16 v18, v123, v43
    v_add_f32_dpp v15, v15, v15 quad_perm:[2,3,0,1] row_mask:0xf bank_mask:0xf
    s_waitcnt vmcnt(7)
    buffer_load_dwordx4 v[120:123], v5, s[28:31], s57 offen offset:256 nt
    v_dot2c_f32_bf16 v17, v124, v44
    v_dot2c_f32_bf16 v18, v125, v45
    v_dot2c_f32_bf16 v17, v126, v46
    v_dot2c_f32_bf16 v18, v127, v47
    v_add_f32_dpp v15, v15, v15 row_half_mirror row_mask:0xf bank_mask:0xf
    s_waitcnt vmcnt(7)
    buffer_load_dwordx4 v[124:127], v5, s[28:31], s57 offen offset:384 nt
    s_sub_u32 s69, s69, 1
    s_cmp_lg_u32 s69, 0
    s_cbranch_scc1 .Lkw
.Lkn:
    s_add_u32 s57, s57, 0x80000
    s_and_b32 s57, s57, 0x7fffff
    v_dot2c_f32_bf16 v11, v64, v32
    v_dot2c_f32_bf16 v12, v65, v33
    v_dot2c_f32_bf16 v11, v66, v34
    v_dot2c_f32_bf16 v12, v67, v35
    v_add_f32 v17, v17, v18
    s_waitcnt vmcnt(4)
    buffer_load_dwordx4 v[64:67], v2, s[28:31], s57 offen offset:0 nt
    v_dot2c_f32_bf16 v11, v68, v36
    v_dot2c_f32_bf16 v12, v69, v37
    v_dot2c_f32_bf16 v11, v70, v38
    v_dot2c_f32_bf16 v12, v71, v39
    v_add_f32_dpp v17, v17, v17 quad_perm:[1,0,3,2] row_mask:0xf bank_mask:0xf
    v_mov_b32 v18, 0
    s_waitcnt vmcnt(4)
    buffer_load_dwordx4 v[68:71], v2, s[28:31], s57 offen offset:128 nt
    v_dot2c_f32_bf16 v11, v72, v40
    v_dot2c_f32_bf16 v12, v73, v41
    v_dot2c_f32_bf16 v11, v74, v42
    v_dot2c_f32_bf16 v12, v75, v43
    v_add_f32_dpp v17, v17, v17 quad_perm:[2,3,0,1] row_mask:0xf bank_mask:0xf
    s_waitcnt vmcnt(4)
    buffer_load_dwordx4 v[72:75], v2, s[28:31], s57 offen offset:256 nt
    v_dot2c_f32_bf16 v11, v76, v44
    v_dot2c_f32_bf16 v12, v77, v45
    v_dot2c_f32_bf16 v11, v78, v46
    v_dot2c_f32_bf16 v12, v79, v47
    v_add_f32_dpp v17, v17, v17 row_half_mirror row_mask:0xf bank_mask:0xf
    s_waitcnt vmcnt(4)
    buffer_load_dwordx4 v[76:79], v2, s[28:31], s57 offen offset:384 nt
    v_dot2c_f32_bf16 v13, v80, v32
    v_dot2c_f32_bf16 v14, v81, v33
    v_dot2c_f32_bf16 v13, v82, v34
    v_dot2c_f32_bf16 v14, v83, v35
    v_add_f32 v11, v11, v12
    v_cvt_pk_bf16_f32 v25, v15, v17
    v_max3_f32 v23, v23, v15, v17
    s_waitcnt vmcnt(4)
    buffer_load_dwordx4 v[80:83], v3, s[28:31], s57 offen offset:0 nt
    v_dot2c_f32_bf16 v13, v84, v36
    v_dot2c_f32_bf16 v14, v85, v37
    v_dot2c_f32_bf16 v13, v86, v38
    v_dot2c_f32_bf16 v14, v87, v39
    v_add_f32_dpp v11, v11, v11 quad_perm:[1,0,3,2] row_mask:0xf bank_mask:0xf
    v_mov_b32 v12, 0
    ds_write_b64 v19, v[24:25]
    v_add_u32 v19, 64, v19
    v_mov_b32 v15, 0
    v_mov_b32 v17, 0
    s_waitcnt vmcnt(4)
    buffer_load_dwordx4 v[84:87], v3, s[28:31], s57 offen offset:128 nt
    v_dot2c_f32_bf16 v13, v88, v40
    v_dot2c_f32_bf16 v14, v89, v41
    v_dot2c_f32_bf16 v13, v90, v42
    v_dot2c_f32_bf16 v14, v91, v43
    v_add_f32_dpp v11, v11, v11 quad_perm:[2,3,0,1] row_mask:0xf bank_mask:0xf
    s_waitcnt vmcnt(4)
    buffer_load_dwordx4 v[88:91], v3, s[28:31], s57 offen offset:256 nt
    v_dot2c_f32_bf16 v13, v92, v44
    v_dot2c_f32_bf16 v14, v93, v45
    v_dot2c_f32_bf16 v13, v94, v46
    v_dot2c_f32_bf16 v14, v95, v47
    v_add_f32_dpp v11, v11, v11 row_half_mirror row_mask:0xf bank_mask:0xf
    s_waitcnt vmcnt(4)
    buffer_load_dwordx4 v[92:95], v3, s[28:31], s57 offen offset:384 nt
    v_dot2c_f32_bf16 v15, v96, v32
    v_dot2c_f32_bf16 v16, v97, v33
    v_dot2c_f32_bf16 v15, v98, v34
    v_dot2c_f32_bf16 v16, v99, v35
    v_add_f32 v13, v13, v14
    s_waitcnt vmcnt(4)
    buffer_load_dwordx4 v[96:99], v4, s[28:31], s57 offen offset:0 nt
    v_dot2c_f32_bf16 v15, v100, v36
    v_dot2c_f32_bf16 v16, v101, v37
    v_dot2c_f32_bf16 v15, v102, v38
    v_dot2c_f32_bf16 v16, v103, v39
    v_add_f32_dpp v13, v13, v13 quad_perm:[1,0,3,2] row_mask:0xf bank_mask:0xf
    v_mov_b32 v14, 0
    s_waitcnt vmcnt(4)
    buffer_load_dwordx4 v[100:103], v4, s[28:31], s57 offen offset:128 nt
    v_dot2c_f32_bf16 v15, v104, v40
    v_dot2c_f32_bf16 v16, v105, v41
    v_dot2c_f32_bf16 v15, v106, v42
    v_dot2c_f32_bf16 v16, v107, v43
    v_add_f32_dpp v13, v13, v13 quad_perm:[2,3,0,1] row_mask:0xf bank_mask:0xf
    s_waitcnt vmcnt(4)
    buffer_load_dwordx4 v[104:107], v4, s[28:31], s57 offen offset:256 nt
    v_dot2c_f32_bf16 v15, v108, v44
    v_dot2c_f32_bf16 v16, v109, v45
    v_dot2c_f32_bf16 v15, v110, v46
    v_dot2c_f32_bf16 v16, v111, v47
    v_add_f32_dpp v13, v13, v13 row_half_mirror row_mask:0xf bank_mask:0xf
    s_waitcnt vmcnt(4)
    buffer_load_dwordx4 v[108:111], v4, s[28:31], s57 offen offset:384 nt
    v_dot2c_f32_bf16 v17, v112, v32
    v_dot2c_f32_bf16 v18, v113, v33
    v_dot2c_f32_bf16 v17, v114, v34
    v_dot2c_f32_bf16 v18, v115, v35
    v_add_f32 v15, v15, v16
    v_cvt_pk_bf16_f32 v24, v11, v13
    v_max3_f32 v23, v23, v11, v13
    s_waitcnt vmcnt(4)
    buffer_load_dwordx4 v[112:115], v5, s[28:31], s57 offen offset:0 nt
    v_dot2c_f32_bf16 v17, v116, v36
    v_dot2c_f32_bf16 v18, v117, v37
    v_dot2c_f32_bf16 v17, v118, v38
    v_dot2c_f32_bf16 v18, v119, v39
    v_add_f32_dpp v15, v15, v15 quad_perm:[1,0,3,2] row_mask:0xf bank_mask:0xf
    v_mov_b32 v16, 0
    v_mov_b32 v11, 0
    v_mov_b32 v13, 0
    s_waitcnt vmcnt(4)
    buffer_load_dwordx4 v[116:119], v5, s[28:31], s57 offen offset:128 nt
    v_dot2c_f32_bf16 v17, v120, v40
    v_dot2c_f32_bf16 v18, v121, v41
    v_dot2c_f32_bf16 v17, v122, v42
    v_dot2c_f32_bf16 v18, v123, v43
    v_add_f32_dpp v15, v15, v15 quad_perm:[2,3,0,1] row_mask:0xf bank_mask:0xf
    s_waitcnt vmcnt(4)
    buffer_load_dwordx4 v[120:123], v5, s[28:31], s57 offen offset:256 nt
    v_dot2c_f32_bf16 v17, v124, v44
    v_dot2c_f32_bf16 v18, v125, v45
    v_dot2c_f32_bf16 v17, v126, v46
    v_dot2c_f32_bf16 v18, v127, v47
    v_add_f32_dpp v15, v15, v15 row_half_mirror row_mask:0xf bank_mask:0xf
    s_waitcnt vmcnt(4)
    buffer_load_dwordx4 v[124:127], v5, s[28:31], s57 offen offset:384 nt
    s_sub_u32 s99, s99, 1
    s_cmp_lg_u32 s99, 0
    s_cbranch_scc1 .Lkn
    s_add_u32 s57, s57, 0x80000
    s_and_b32 s57, s57, 0x7fffff
    s_mov_b64 s[28:29], s[32:33]
    v_dot2c_f32_bf16 v11, v64, v32
    v_dot2c_f32_bf16 v12, v65, v33
    v_dot2c_f32_bf16 v11, v66, v34
    v_dot2c_f32_bf16 v12, v67, v35
    v_add_f32 v17, v17, v18
    ds_read_b64 v[152:153], v206
    v_add_u32 v206, 64, v206
    s_waitcnt vmcnt(4)
    buffer_load_dwordx4 v[64:67], v2, s[28:31], s57 offen offset:0 nt
    v_dot2c_f32_bf16 v11, v68, v36
    v_dot2c_f32_bf16 v12, v69, v37
    v_dot2c_f32_bf16 v11, v70, v38
    v_dot2c_f32_bf16 v12, v71, v39
    v_add_f32_dpp v17, v17, v17 quad_perm:[1,0,3,2] row_mask:0xf bank_mask:0xf
    v_mov_b32 v18, 0
    s_waitcnt vmcnt(4)
    buffer_load_dwordx4 v[68:71], v2, s[28:31], s57 offen offset:128 nt
    v_dot2c_f32_bf16 v11, v72, v40
    v_dot2c_f32_bf16 v12, v73, v41
    v_dot2c_f32_bf16 v11, v74, v42
    v_dot2c_f32_bf16 v12, v75, v43
    v_add_f32_dpp v17, v17, v17 quad_perm:[2,3,0,1] row_mask:0xf bank_mask:0xf
    s_waitcnt vmcnt(4)
    buffer_load_dwordx4 v[72:75], v2, s[28:31], s57 offen offset:256 nt
    v_dot2c_f32_bf16 v11, v76, v44
    v_dot2c_f32_bf16 v12, v77, v45
    v_dot2c_f32_bf16 v11, v78, v46
    v_dot2c_f32_bf16 v12, v79, v47
    v_add_f32_dpp v17, v17, v17 row_half_mirror row_mask:0xf bank_mask:0xf
    s_waitcnt vmcnt(4)
    buffer_load_dwordx4 v[76:79], v2, s[28:31], s57 offen offset:384 nt
    v_dot2c_f32_bf16 v13, v80, v32
    v_dot2c_f32_bf16 v14, v81, v33
    v_dot2c_f32_bf16 v13, v82, v34
    v_dot2c_f32_bf16 v14, v83, v35
    v_add_f32 v11, v11, v12
    v_cvt_pk_bf16_f32 v25, v15, v17
    v_max3_f32 v23, v23, v15, v17
    s_waitcnt vmcnt(4)
    buffer_load_dwordx4 v[80:83], v3, s[28:31], s57 offen offset:0 nt
    v_dot2c_f32_bf16 v13, v84, v36
    v_dot2c_f32_bf16 v14, v85, v37
    v_dot2c_f32_bf16 v13, v86, v38
    v_dot2c_f32_bf16 v14, v87, v39
    v_add_f32_dpp v11, v11, v11 quad_perm:[1,0,3,2] row_mask:0xf bank_mask:0xf
    v_mov_b32 v12, 0
    ds_write_b64 v19, v[24:25]
    v_add_u32 v19, 64, v19
    v_mov_b32 v15, 0
    v_mov_b32 v17, 0
    v_mov_b32 v176, v23
    s_waitcnt vmcnt(4)
    buffer_load_dwordx4 v[84:87], v3, s[28:31], s57 offen offset:128 nt
    v_dot2c_f32_bf16 v13, v88, v40
    v_dot2c_f32_bf16 v14, v89, v41
    v_dot2c_f32_bf16 v13, v90, v42
    v_dot2c_f32_bf16 v14, v91, v43
    v_add_f32_dpp v11, v11, v11 quad_perm:[2,3,0,1] row_mask:0xf bank_mask:0xf
    v_max_f32_dpp v176, v176, v176 row_mirror row_mask:0xf bank_mask:0xf
    s_waitcnt vmcnt(4)
    buffer_load_dwordx4 v[88:91], v3, s[28:31], s57 offen offset:256 nt
    v_dot2c_f32_bf16 v13, v92, v44
    v_dot2c_f32_bf16 v14, v93, v45
    v_dot2c_f32_bf16 v13, v94, v46
    v_dot2c_f32_bf16 v14, v95, v47
    v_add_f32_dpp v11, v11, v11 row_half_mirror row_mask:0xf bank_mask:0xf
    v_mov_b32 v177, v176
    s_waitcnt vmcnt(4)
    buffer_load_dwordx4 v[92:95], v3, s[28:31], s57 offen offset:384 nt
    v_dot2c_f32_bf16 v15, v96, v32
    v_dot2c_f32_bf16 v16, v97, v33
    v_dot2c_f32_bf16 v15, v98, v34
    v_dot2c_f32_bf16 v16, v99, v35
    v_add_f32 v13, v13, v14
    v_permlane16_swap_b32 v176, v177
    s_waitcnt vmcnt(4)
    buffer_load_dwordx4 v[96:99], v4, s[28:31], s57 offen offset:0 nt
    v_dot2c_f32_bf16 v15, v100, v36
    v_dot2c_f32_bf16 v16, v101, v37
    v_dot2c_f32_bf16 v15, v102, v38
    v_dot2c_f32_bf16 v16, v103, v39
    v_add_f32_dpp v13, v13, v13 quad_perm:[1,0,3,2] row_mask:0xf bank_mask:0xf
    v_mov_b32 v14, 0
    v_max_f32 v176, v176, v177
    v_mov_b32 v177, v176
    s_waitcnt vmcnt(4)
    buffer_load_dwordx4 v[100:103], v4, s[28:31], s57 offen offset:128 nt
    v_dot2c_f32_bf16 v15, v104, v40
    v_dot2c_f32_bf16 v16, v105, v41
    v_dot2c_f32_bf16 v15, v106, v42
    v_dot2c_f32_bf16 v16, v107, v43
    v_add_f32_dpp v13, v13, v13 quad_perm:[2,3,0,1] row_mask:0xf bank_mask:0xf
    v_permlane32_swap_b32 v176, v177
    s_waitcnt vmcnt(4)
    buffer_load_dwordx4 v[104:107], v4, s[28:31], s57 offen offset:256 nt
    v_dot2c_f32_bf16 v15, v108, v44
    v_dot2c_f32_bf16 v16, v109, v45
    v_dot2c_f32_bf16 v15, v110, v46
    v_dot2c_f32_bf16 v16, v111, v47
    v_add_f32_dpp v13, v13, v13 row_half_mirror row_mask:0xf bank_mask:0xf
    v_max_f32 v176, v176, v177
    v_mul_f32_e64 v10, -s59, v176
    s_waitcnt vmcnt(4)
    buffer_load_dwordx4 v[108:111], v4, s[28:31], s57 offen offset:384 nt
    v_dot2c_f32_bf16 v17, v112, v32
    v_dot2c_f32_bf16 v18, v113, v33
    v_dot2c_f32_bf16 v17, v114, v34
    v_dot2c_f32_bf16 v18, v115, v35
    v_add_f32 v15, v15, v16
    v_cvt_pk_bf16_f32 v24, v11, v13
    v_max3_f32 v23, v23, v11, v13
    s_waitcnt lgkmcnt(0)
    v_lshlrev_b32 v144, 16, v152
    v_and_b32 v145, 0xffff0000, v152
    v_lshlrev_b32 v146, 16, v153
    v_fma_f32 v144, v144, s59, v10
    v_fma_f32 v145, v145, s59, v10
    v_fma_f32 v146, v146, s59, v10
    s_waitcnt vmcnt(4)
    buffer_load_dwordx4 v[112:115], v5, s[28:31], s57 offen offset:0 nt
    v_dot2c_f32_bf16 v17, v116, v36
    v_dot2c_f32_bf16 v18, v117, v37
    v_dot2c_f32_bf16 v17, v118, v38
    v_dot2c_f32_bf16 v18, v119, v39
    v_add_f32_dpp v15, v15, v15 quad_perm:[1,0,3,2] row_mask:0xf bank_mask:0xf
    v_mov_b32 v16, 0
    v_mov_b32 v11, 0
    v_mov_b32 v13, 0
    v_exp_f32 v144, v144
    v_exp_f32 v145, v145
    v_exp_f32 v146, v146
    s_waitcnt vmcnt(4)
    buffer_load_dwordx4 v[116:119], v5, s[28:31], s57 offen offset:128 nt
    v_dot2c_f32_bf16 v17, v120, v40
    v_dot2c_f32_bf16 v18, v121, v41
    v_dot2c_f32_bf16 v17, v122, v42
    v_dot2c_f32_bf16 v18, v123, v43
    v_add_f32_dpp v15, v15, v15 quad_perm:[2,3,0,1] row_mask:0xf bank_mask:0xf
    v_cvt_pk_bf16_f32 v144, v144, v144
    v_cvt_pk_bf16_f32 v145, v145, v145
    v_cvt_pk_bf16_f32 v146, v146, v146
    s_waitcnt vmcnt(4)
    buffer_load_dwordx4 v[120:123], v5, s[28:31], s57 offen offset:256 nt
    v_dot2c_f32_bf16 v17, v124, v44
    v_dot2c_f32_bf16 v18, v125, v45
    v_dot2c_f32_bf16 v17, v126, v46
    v_dot2c_f32_bf16 v18, v127, v47
    v_add_f32_dpp v15, v15, v15 row_half_mirror row_mask:0xf bank_mask:0xf
    v_and_b32 v128, v6, v144
    v_and_b32 v129, v7, v144
    v_and_b32 v130, v8, v144
    v_and_b32 v131, v9, v144
    v_and_b32 v132, v6, v145
    v_and_b32 v133, v7, v145
    v_and_b32 v134, v8, v145
    v_and_b32 v135, v9, v145
    v_and_b32 v136, v6, v146
    v_and_b32 v137, v7, v146
    v_and_b32 v138, v8, v146
    v_and_b32 v139, v9, v146
    s_waitcnt vmcnt(4)
    buffer_load_dwordx4 v[124:127], v5, s[28:31], s57 offen offset:384 nt
    s_add_u32 s57, s57, 0x80000
    s_and_b32 s57, s57, 0x7fffff
    v_mfma_f32_16x16x32_bf16 v[48:51], v[128:131], v[64:67], 0
    v_and_b32 v144, 0xffff0000, v153
    v_fma_f32 v144, v144, s59, v10
    v_add_f32 v17, v17, v18
    s_waitcnt vmcnt(4)
    buffer_load_dwordx4 v[64:67], v2, s[28:31], s57 offen offset:0 nt
    v_mfma_f32_16x16x32_bf16 v[52:55], v[128:131], v[68:71], 0
    v_exp_f32 v144, v144
    ds_read_b64 v[152:153], v206
    v_add_u32 v206, 64, v206
    v_add_f32_dpp v17, v17, v17 quad_perm:[1,0,3,2] row_mask:0xf bank_mask:0xf
    s_waitcnt vmcnt(4)
    buffer_load_dwordx4 v[68:71], v2, s[28:31], s57 offen offset:128 nt
    v_mfma_f32_16x16x32_bf16 v[56:59], v[128:131], v[72:75], 0
    v_cvt_pk_bf16_f32 v144, v144, v144
    v_add_f32_dpp v17, v17, v17 quad_perm:[2,3,0,1] row_mask:0xf bank_mask:0xf
    s_waitcnt vmcnt(4)
    buffer_load_dwordx4 v[72:75], v2, s[28:31], s57 offen offset:256 nt
    v_mfma_f32_16x16x32_bf16 v[60:63], v[128:131], v[76:79], 0
    v_and_b32 v140, v6, v144
    v_and_b32 v141, v7, v144
    v_and_b32 v142, v8, v144
    v_and_b32 v143, v9, v144
    v_add_f32_dpp v17, v17, v17 row_half_mirror row_mask:0xf bank_mask:0xf
    s_lshl_b32 s60, s52, 11
    s_add_u32 s60, s60, 4096
    v_lshl_add_u32 v207, v1, 4, s60
    s_waitcnt vmcnt(4)
    buffer_load_dwordx4 v[76:79], v2, s[28:31], s57 offen offset:384 nt
    v_mfma_f32_16x16x32_bf16 v[48:51], v[132:135], v[80:83], v[48:51]
    s_waitcnt lgkmcnt(0)
    v_lshlrev_b32 v144, 16, v152
    v_fma_f32 v144, v144, s59, v10
    v_cvt_pk_bf16_f32 v25, v15, v17
    v_max3_f32 v23, v23, v15, v17
    s_lshl_b32 s60, s2, 2
    s_add_u32 s63, s60, s52
    s_lshl_b32 s60, s63, 8
    s_add_u32 s60, s60, 523520
    v_lshlrev_b32 v13, 4, v1
    s_waitcnt vmcnt(4)
    buffer_load_dwordx4 v[80:83], v3, s[28:31], s57 offen offset:0 nt
    v_mfma_f32_16x16x32_bf16 v[52:55], v[132:135], v[84:87], v[52:55]
    v_exp_f32 v144, v144
    ds_write_b64 v19, v[24:25]
    ds_read_b128 v[148:151], v207
    s_waitcnt vmcnt(4)
    buffer_load_dwordx4 v[84:87], v3, s[28:31], s57 offen offset:128 nt
    v_mfma_f32_16x16x32_bf16 v[56:59], v[132:135], v[88:91], v[56:59]
    v_cvt_pk_bf16_f32 v144, v144, v144
    v_max_f32_dpp v23, v23, v23 row_mirror row_mask:0xf bank_mask:0xf
    s_waitcnt vmcnt(4)
    buffer_load_dwordx4 v[88:91], v3, s[28:31], s57 offen offset:256 nt
    v_mfma_f32_16x16x32_bf16 v[60:63], v[132:135], v[92:95], v[60:63]
    v_and_b32 v128, v6, v144
    v_and_b32 v129, v7, v144
    v_and_b32 v130, v8, v144
    v_and_b32 v131, v9, v144
    v_mov_b32 v177, v23
    s_waitcnt lgkmcnt(0)
    s_mov_b32 exec_lo, 0
    s_mov_b32 exec_hi, 0xffff0000
    buffer_store_dwordx4 v[148:151], v13, s[36:39], s60 offen sc1
    s_mov_b64 exec, -1
    s_waitcnt vmcnt(7)
    buffer_load_dwordx4 v[92:95], v3, s[28:31], s57 offen offset:384 nt
    v_mfma_f32_16x16x32_bf16 v[48:51], v[136:139], v[96:99], v[48:51]
    v_and_b32 v144, 0xffff0000, v152
    v_fma_f32 v144, v144, s59, v10
    v_permlane16_swap_b32 v23, v177
    v_lshlrev_b32 v156, 16, v148
    v_and_b32 v157, 0xffff0000, v148
    v_lshlrev_b32 v158, 16, v149
    v_and_b32 v159, 0xffff0000, v149
    v_lshlrev_b32 v160, 16, v150
    v_and_b32 v161, 0xffff0000, v150
    v_lshlrev_b32 v162, 16, v151
    v_and_b32 v163, 0xffff0000, v151
    s_waitcnt vmcnt(7)
    buffer_load_dwordx4 v[96:99], v4, s[28:31], s57 offen offset:0 nt
    v_mfma_f32_16x16x32_bf16 v[52:55], v[136:139], v[100:103], v[52:55]
    v_exp_f32 v144, v144
    v_max_f32 v23, v23, v177
    v_mov_b32 v177, v23
    s_waitcnt vmcnt(7)
    buffer_load_dwordx4 v[100:103], v4, s[28:31], s57 offen offset:128 nt
    v_mfma_f32_16x16x32_bf16 v[56:59], v[136:139], v[104:107], v[56:59]
    v_cvt_pk_bf16_f32 v144, v144, v144
    v_permlane32_swap_b32 v23, v177
    s_waitcnt vmcnt(7)
    buffer_load_dwordx4 v[104:107], v4, s[28:31], s57 offen offset:256 nt
    v_mfma_f32_16x16x32_bf16 v[60:63], v[136:139], v[108:111], v[60:63]
    v_and_b32 v132, v6, v144
    v_and_b32 v133, v7, v144
    v_and_b32 v134, v8, v144
    v_and_b32 v135, v9, v144
    v_max_f32 v23, v23, v177
    v_mul_f32_e64 v179, -s59, v23
    s_waitcnt vmcnt(7)
    buffer_load_dwordx4 v[108:111], v4, s[28:31], s57 offen offset:384 nt
    v_mfma_f32_16x16x32_bf16 v[48:51], v[140:143], v[112:115], v[48:51]
    v_lshlrev_b32 v144, 16, v153
    v_fma_f32 v144, v144, s59, v10
    v_fma_f32 v156, v156, s59, v179
    v_fma_f32 v157, v157, s59, v179
    v_fma_f32 v158, v158, s59, v179
    v_fma_f32 v159, v159, s59, v179
    v_fma_f32 v160, v160, s59, v179
    v_fma_f32 v161, v161, s59, v179
    v_fma_f32 v162, v162, s59, v179
    v_fma_f32 v163, v163, s59, v179
    s_waitcnt vmcnt(7)
    buffer_load_dwordx4 v[112:115], v5, s[28:31], s57 offen offset:0 nt
    v_mfma_f32_16x16x32_bf16 v[52:55], v[140:143], v[116:119], v[52:55]
    v_exp_f32 v144, v144
    v_exp_f32 v156, v156
    v_exp_f32 v157, v157
    v_exp_f32 v158, v158
    v_exp_f32 v159, v159
    v_exp_f32 v160, v160
    v_exp_f32 v161, v161
    v_exp_f32 v162, v162
    v_exp_f32 v163, v163
    s_waitcnt vmcnt(7)
    buffer_load_dwordx4 v[116:119], v5, s[28:31], s57 offen offset:128 nt
    v_mfma_f32_16x16x32_bf16 v[56:59], v[140:143], v[120:123], v[56:59]
    v_cvt_pk_bf16_f32 v144, v144, v144
    v_add_f32 v156, v156, v160
    v_add_f32 v157, v157, v161
    v_add_f32 v158, v158, v162
    v_add_f32 v159, v159, v163
    s_waitcnt vmcnt(7)
    buffer_load_dwordx4 v[120:123], v5, s[28:31], s57 offen offset:256 nt
    v_mfma_f32_16x16x32_bf16 v[60:63], v[140:143], v[124:127], v[60:63]
    v_and_b32 v136, v6, v144
    v_and_b32 v137, v7, v144
    v_and_b32 v138, v8, v144
    v_and_b32 v139, v9, v144
    v_add_f32 v156, v156, v157
    v_add_f32 v158, v158, v159
    v_add_f32 v182, v156, v158
    s_waitcnt vmcnt(7)
    buffer_load_dwordx4 v[124:127], v5, s[28:31], s57 offen offset:384 nt
    s_add_u32 s57, s57, 0x80000
    s_and_b32 s57, s57, 0x7fffff
    v_mfma_f32_16x16x32_bf16 v[48:51], v[128:131], v[64:67], v[48:51]
    v_and_b32 v144, 0xffff0000, v153
    v_fma_f32 v144, v144, s59, v10
    v_add_f32_dpp v182, v182, v182 quad_perm:[1,0,3,2] row_mask:0xf bank_mask:0xf
    s_nop 1
    v_add_f32_dpp v182, v182, v182 quad_perm:[2,3,0,1] row_mask:0xf bank_mask:0xf
    s_waitcnt vmcnt(4)
    buffer_load_dwordx4 v[64:67], v2, s[28:31], s57 offen offset:0 nt
    v_mfma_f32_16x16x32_bf16 v[52:55], v[128:131], v[68:71], v[52:55]
    v_exp_f32 v144, v144
    ds_read_b64 v[152:153], v206
    v_add_u32 v206, 64, v206
    v_add_f32_dpp v182, v182, v182 row_half_mirror row_mask:0xf bank_mask:0xf
    s_nop 1
    v_add_f32_dpp v182, v182, v182 row_mirror row_mask:0xf bank_mask:0xf
    s_waitcnt vmcnt(4)
    buffer_load_dwordx4 v[68:71], v2, s[28:31], s57 offen offset:128 nt
    v_mfma_f32_16x16x32_bf16 v[56:59], v[128:131], v[72:75], v[56:59]
    v_cvt_pk_bf16_f32 v144, v144, v144
    v_mov_b32 v177, v182
    s_nop 1
    v_permlane16_swap_b32 v182, v177
    s_waitcnt vmcnt(4)
    buffer_load_dwordx4 v[72:75], v2, s[28:31], s57 offen offset:256 nt
    v_mfma_f32_16x16x32_bf16 v[60:63], v[128:131], v[76:79], v[60:63]
    v_and_b32 v140, v6, v144
    v_and_b32 v141, v7, v144
    v_and_b32 v142, v8, v144
    v_and_b32 v143, v9, v144
    v_add_f32 v182, v182, v177
    v_mov_b32 v177, v182
    s_nop 1
    v_permlane32_swap_b32 v182, v177
    s_waitcnt vmcnt(4)
    buffer_load_dwordx4 v[76:79], v2, s[28:31], s57 offen offset:384 nt
    v_mfma_f32_16x16x32_bf16 v[48:51], v[132:135], v[80:83], v[48:51]
    s_waitcnt lgkmcnt(0)
    v_lshlrev_b32 v144, 16, v152
    v_fma_f32 v144, v144, s59, v10
    v_add_f32 v182, v182, v177
    v_mov_b32 v180, v23
    v_mov_b32 v181, s55
    v_mov_b32 v183, s55
    s_lshl_b32 s60, s2, 6
    s_add_u32 s60, s60, 49152
    v_mov_b32 v16, 0
    s_getreg_b32 s63, hwreg(HW_REG_XCC_ID, 2, 1)
    s_lshr_b32 s64, s40, 9
    s_lshr_b32 s65, s40, 18
    s_or_b32 s64, s64, s65
    s_and_b32 s64, s64, 6
    s_or_b32 s63, s63, s64
    s_cmp_eq_u32 s52, 1
    s_cselect_b32 s63, s63, 0
    v_xor_b32 v183, s63, v183
    s_lshl_b32 s64, s52, 4
    v_mov_b32 v164, s64
    v_mov_b32 v166, 1
    v_lshlrev_b32 v165, 4, v1
    s_mov_b32 s65, s60
    s_waitcnt vmcnt(4)
    buffer_load_dwordx4 v[80:83], v3, s[28:31], s57 offen offset:0 nt
    v_mfma_f32_16x16x32_bf16 v[52:55], v[132:135], v[84:87], v[52:55]
    v_exp_f32 v144, v144
    s_mov_b64 exec, 1
    ds_write_b128 v164, v[180:183] offset:7168
    ds_add_rtn_u32 v167, v16, v166 offset:536
    s_mov_b64 exec, -1
    ds_read_b128 v[168:171], v165 offset:7168
    s_waitcnt vmcnt(8)
    buffer_load_dwordx4 v[84:87], v3, s[28:31], s57 offen offset:128 nt
    v_mfma_f32_16x16x32_bf16 v[56:59], v[132:135], v[88:91], v[56:59]
    v_cvt_pk_bf16_f32 v144, v144, v144
    s_lshl_b32 s98, s54, 9
    s_add_u32 s98, s98, 49152
    v_and_b32 v28, 31, v1
    v_lshlrev_b32 v28, 4, v28
    v_lshrrev_b32 v27, 1, v28
    v_add_u32 v27, 12288, v27
    s_waitcnt vmcnt(8)
    buffer_load_dwordx4 v[88:91], v3, s[28:31], s57 offen offset:256 nt
    v_mfma_f32_16x16x32_bf16 v[60:63], v[132:135], v[92:95], v[60:63]
    v_and_b32 v128, v6, v144
    v_and_b32 v129, v7, v144
    v_and_b32 v130, v8, v144
    v_and_b32 v131, v9, v144
    s_waitcnt lgkmcnt(0)
    v_readfirstlane_b32 s64, v167
    s_cmp_eq_u32 s64, 3
    s_cselect_b64 exec, 15, 0
    buffer_store_dwordx4 v[168:171], v165, s[36:39], s65 offen sc1
    s_mov_b64 exec, -1
    v_lshrrev_b32 v13, 5, v1
    v_lshlrev_b32 v13, 10, v13
    v_and_b32 v14, 7, v1
    v_lshl_add_u32 v13, v14, 5, v13
    v_bfe_u32 v14, v1, 4, 1
    v_lshl_add_u32 v13, v14, 4, v13
    s_waitcnt vmcnt(8)
    buffer_load_dwordx4 v[92:95], v3, s[28:31], s57 offen offset:384 nt
    v_mfma_f32_16x16x32_bf16 v[48:51], v[136:139], v[96:99], v[48:51]
    v_and_b32 v144, 0xffff0000, v152
    v_fma_f32 v144, v144, s59, v10
    s_lshl_b32 s60, s52, 11
    v_add_u32 v13, s60, v13
    v_lshlrev_b32 v14, 4, v1
    v_lshlrev_b32 v15, 3, v1
    v_mov_b32 v17, 1
    v_lshlrev_b32 v208, 2, v1
    s_waitcnt vmcnt(8)
    buffer_load_dwordx4 v[96:99], v4, s[28:31], s57 offen offset:0 nt
    v_mfma_f32_16x16x32_bf16 v[52:55], v[136:139], v[100:103], v[52:55]
    v_exp_f32 v144, v144
    v_mov_b32 v200, 7168
    v_mov_b32 v201, 7168
    v_mov_b32 v202, 7168
    v_mov_b32 v203, 7168
    v_mov_b32 v26, 1
    v_mov_b32 v199, 3
    s_waitcnt vmcnt(8)
    buffer_load_dwordx4 v[100:103], v4, s[28:31], s57 offen offset:128 nt
    v_mfma_f32_16x16x32_bf16 v[56:59], v[136:139], v[104:107], v[56:59]
    v_cvt_pk_bf16_f32 v144, v144, v144
    s_add_u32 s43, s61, 7340032
    v_add_u32 v20, 128, v20
    s_mov_b64 s[46:47], 1
    s_mov_b32 s45, 0
    v_mov_b32 v211, 0x100
    s_mov_b32 s97, 1
    s_mov_b32 s101, 0
    s_mov_b32 s99, 10
    s_waitcnt vmcnt(8)
    buffer_load_dwordx4 v[104:107], v4, s[28:31], s57 offen offset:256 nt
    v_mfma_f32_16x16x32_bf16 v[60:63], v[136:139], v[108:111], v[60:63]
    v_and_b32 v132, v6, v144
    v_and_b32 v133, v7, v144
    v_and_b32 v134, v8, v144
    v_and_b32 v135, v9, v144
    s_xor_b32 s60, s53, s54
    s_and_b32 s60, s60, 7
    s_lshl_b32 s60, s60, 2
    s_add_u32 s60, s60, s52
    s_cmp_eq_u32 s60, 6
    s_cselect_b32 s47, 5, -1
    s_waitcnt vmcnt(8)
    buffer_load_dwordx4 v[108:111], v4, s[28:31], s57 offen offset:384 nt
    v_mfma_f32_16x16x32_bf16 v[48:51], v[140:143], v[112:115], v[48:51]
    v_lshlrev_b32 v144, 16, v153
    v_fma_f32 v144, v144, s59, v10
    s_waitcnt vmcnt(8)
    buffer_load_dwordx4 v[112:115], v5, s[28:31], s57 offen offset:0 nt
    v_mfma_f32_16x16x32_bf16 v[52:55], v[140:143], v[116:119], v[52:55]
    v_exp_f32 v144, v144
    s_waitcnt vmcnt(8)
    buffer_load_dwordx4 v[116:119], v5, s[28:31], s57 offen offset:128 nt
    v_mfma_f32_16x16x32_bf16 v[56:59], v[140:143], v[120:123], v[56:59]
    v_cvt_pk_bf16_f32 v144, v144, v144
    s_waitcnt vmcnt(4)
    buffer_load_dwordx4 v[120:123], v5, s[28:31], s57 offen offset:256 nt
    v_mfma_f32_16x16x32_bf16 v[60:63], v[140:143], v[124:127], v[60:63]
    v_and_b32 v136, v6, v144
    v_and_b32 v137, v7, v144
    v_and_b32 v138, v8, v144
    v_and_b32 v139, v9, v144
    s_waitcnt vmcnt(4)
    buffer_load_dwordx4 v[124:127], v5, s[28:31], s57 offen offset:384 nt
.Lvn:
    s_add_u32 s57, s57, 0x80000
    s_and_b32 s57, s57, 0x7fffff
    s_sub_u32 s99, s99, 1
    s_cmp_lg_u32 s99, 0
    s_cbranch_scc1 .Lv1
    buffer_load_dwordx4 v[184:187], v28, s[36:39], s98 offen sc1
    buffer_load_dwordx2 v[190:191], v27, s[36:39], 0 offen sc1
.Lv1:
    s_cmp_eq_u32 s99, s47
    s_cbranch_scc1 .Lsum
.Lsumok:
    v_mfma_f32_16x16x32_bf16 v[48:51], v[128:131], v[64:67], v[48:51]
    v_and_b32 v144, 0xffff0000, v153
    v_fma_f32 v144, v144, s59, v10
    s_waitcnt vmcnt(4)
    buffer_load_dwordx4 v[64:67], v2, s[28:31], s57 offen offset:0 nt
    v_mfma_f32_16x16x32_bf16 v[52:55], v[128:131], v[68:71], v[52:55]
    v_exp_f32 v144, v144
    ds_read_b64 v[152:153], v206
    v_add_u32 v206, 64, v206
    s_waitcnt vmcnt(4)
    buffer_load_dwordx4 v[68:71], v2, s[28:31], s57 offen offset:128 nt
    v_mfma_f32_16x16x32_bf16 v[56:59], v[128:131], v[72:75], v[56:59]
    v_cvt_pk_bf16_f32 v144, v144, v144
    s_waitcnt vmcnt(4)
    buffer_load_dwordx4 v[72:75], v2, s[28:31], s57 offen offset:256 nt
    v_mfma_f32_16x16x32_bf16 v[60:63], v[128:131], v[76:79], v[60:63]
    v_and_b32 v140, v6, v144
    v_and_b32 v141, v7, v144
    v_and_b32 v142, v8, v144
    v_and_b32 v143, v9, v144
    s_waitcnt vmcnt(4)
    buffer_load_dwordx4 v[76:79], v2, s[28:31], s57 offen offset:384 nt
    v_mfma_f32_16x16x32_bf16 v[48:51], v[132:135], v[80:83], v[48:51]
    s_waitcnt lgkmcnt(0)
    v_lshlrev_b32 v144, 16, v152
    v_fma_f32 v144, v144, s59, v10
    s_waitcnt vmcnt(4)
    buffer_load_dwordx4 v[80:83], v3, s[28:31], s57 offen offset:0 nt
    v_mfma_f32_16x16x32_bf16 v[52:55], v[132:135], v[84:87], v[52:55]
    v_exp_f32 v144, v144
    s_waitcnt vmcnt(4)
    buffer_load_dwordx4 v[84:87], v3, s[28:31], s57 offen offset:128 nt
    v_mfma_f32_16x16x32_bf16 v[56:59], v[132:135], v[88:91], v[56:59]
    v_cvt_pk_bf16_f32 v144, v144, v144
    s_waitcnt vmcnt(4)
    buffer_load_dwordx4 v[88:91], v3, s[28:31], s57 offen offset:256 nt
    v_mfma_f32_16x16x32_bf16 v[60:63], v[132:135], v[92:95], v[60:63]
    v_and_b32 v128, v6, v144
    v_and_b32 v129, v7, v144
    v_and_b32 v130, v8, v144
    v_and_b32 v131, v9, v144
    s_waitcnt vmcnt(4)
    buffer_load_dwordx4 v[92:95], v3, s[28:31], s57 offen offset:384 nt
    v_mfma_f32_16x16x32_bf16 v[48:51], v[136:139], v[96:99], v[48:51]
    v_and_b32 v144, 0xffff0000, v152
    v_fma_f32 v144, v144, s59, v10
    s_waitcnt vmcnt(4)
    buffer_load_dwordx4 v[96:99], v4, s[28:31], s57 offen offset:0 nt
    v_mfma_f32_16x16x32_bf16 v[52:55], v[136:139], v[100:103], v[52:55]
    v_exp_f32 v144, v144
    s_waitcnt vmcnt(4)
    buffer_load_dwordx4 v[100:103], v4, s[28:31], s57 offen offset:128 nt
    v_mfma_f32_16x16x32_bf16 v[56:59], v[136:139], v[104:107], v[56:59]
    v_cvt_pk_bf16_f32 v144, v144, v144
    s_waitcnt vmcnt(4)
    buffer_load_dwordx4 v[104:107], v4, s[28:31], s57 offen offset:256 nt
    v_mfma_f32_16x16x32_bf16 v[60:63], v[136:139], v[108:111], v[60:63]
    v_and_b32 v132, v6, v144
    v_and_b32 v133, v7, v144
    v_and_b32 v134, v8, v144
    v_and_b32 v135, v9, v144
    s_waitcnt vmcnt(4)
    buffer_load_dwordx4 v[108:111], v4, s[28:31], s57 offen offset:384 nt
    v_mfma_f32_16x16x32_bf16 v[48:51], v[140:143], v[112:115], v[48:51]
    v_lshlrev_b32 v144, 16, v153
    v_fma_f32 v144, v144, s59, v10
    s_waitcnt vmcnt(4)
    buffer_load_dwordx4 v[112:115], v5, s[28:31], s57 offen offset:0 nt
    v_mfma_f32_16x16x32_bf16 v[52:55], v[140:143], v[116:119], v[52:55]
    v_exp_f32 v144, v144
    s_waitcnt vmcnt(4)
    buffer_load_dwordx4 v[116:119], v5, s[28:31], s57 offen offset:128 nt
    v_mfma_f32_16x16x32_bf16 v[56:59], v[140:143], v[120:123], v[56:59]
    v_cvt_pk_bf16_f32 v144, v144, v144
    s_waitcnt vmcnt(4)
    buffer_load_dwordx4 v[120:123], v5, s[28:31], s57 offen offset:256 nt
    v_mfma_f32_16x16x32_bf16 v[60:63], v[140:143], v[124:127], v[60:63]
    v_and_b32 v136, v6, v144
    v_and_b32 v137, v7, v144
    v_and_b32 v138, v8, v144
    v_and_b32 v139, v9, v144
    s_waitcnt vmcnt(4)
    buffer_load_dwordx4 v[124:127], v5, s[28:31], s57 offen offset:384 nt
    s_cmp_lg_u32 s99, 0
    s_cbranch_scc1 .Lvn
    s_add_u32 s57, s57, 0x80000
    s_and_b32 s57, s57, 0x7fffff
    v_mfma_f32_16x16x32_bf16 v[48:51], v[128:131], v[64:67], v[48:51]
    v_and_b32 v144, 0xffff0000, v153
    v_fma_f32 v144, v144, s59, v10
    v_mov_b32 v22, 1
    s_mov_b64 exec, 1
    buffer_atomic_add v22, v21, s[36:39], 0 offen sc0 sc1 nt
    s_mov_b64 exec, -1
    v_xor_b32 v187, s55, v187
    v_cmp_ne_u32 vcc, s55, v185
    v_cmp_lt_u32 s[66:67], 7, v187
    s_or_b64 vcc, vcc, s[66:67]
    s_cbranch_vccnz .Lmlchk
.Lmlok:
    v_cmp_ne_u32 vcc, s55, v190
    s_cbranch_vccnz .Lrd
.Lrdok:
    v_mov_b32 v188, v184
    v_and_b32 v189, 15, v191
    v_cmp_ne_u32 s[64:65], 4, v189
    s_waitcnt vmcnt(7)
    buffer_load_dwordx4 v[64:67], v2, s[28:31], s57 offen offset:0 nt
    v_mfma_f32_16x16x32_bf16 v[52:55], v[128:131], v[68:71], v[52:55]
    v_exp_f32 v144, v144
    ds_read_b64 v[152:153], v206
    v_add_u32 v206, 64, v206
    v_max_f32_dpp v188, v188, v188 quad_perm:[1,0,3,2] row_mask:0xf bank_mask:0xf
    v_add_u32_dpp v191, v191, v191 quad_perm:[1,0,3,2] row_mask:0xf bank_mask:0xf
    s_nop 0
    v_max_f32_dpp v188, v188, v188 quad_perm:[2,3,0,1] row_mask:0xf bank_mask:0xf
    v_add_u32_dpp v191, v191, v191 quad_perm:[2,3,0,1] row_mask:0xf bank_mask:0xf
    s_waitcnt vmcnt(7)
    buffer_load_dwordx4 v[68:71], v2, s[28:31], s57 offen offset:128 nt
    v_mfma_f32_16x16x32_bf16 v[56:59], v[128:131], v[72:75], v[56:59]
    v_cvt_pk_bf16_f32 v144, v144, v144
    v_max_f32_dpp v188, v188, v188 row_half_mirror row_mask:0xf bank_mask:0xf
    v_add_u32_dpp v191, v191, v191 row_half_mirror row_mask:0xf bank_mask:0xf
    s_nop 0
    v_max_f32_dpp v188, v188, v188 row_mirror row_mask:0xf bank_mask:0xf
    v_add_u32_dpp v191, v191, v191 row_mirror row_mask:0xf bank_mask:0xf
    s_waitcnt vmcnt(7)
    buffer_load_dwordx4 v[72:75], v2, s[28:31], s57 offen offset:256 nt
    v_mfma_f32_16x16x32_bf16 v[60:63], v[128:131], v[76:79], v[60:63]
    v_and_b32 v140, v6, v144
    v_and_b32 v141, v7, v144
    v_and_b32 v142, v8, v144
    v_and_b32 v143, v9, v144
    v_mov_b32 v189, v188
    v_readlane_b32 s60, v191, 0
    v_readlane_b32 s63, v191, 16
    v_permlane16_swap_b32 v188, v189
    s_waitcnt vmcnt(7)
    buffer_load_dwordx4 v[76:79], v2, s[28:31], s57 offen offset:384 nt
    v_mfma_f32_16x16x32_bf16 v[48:51], v[132:135], v[80:83], v[48:51]
    s_waitcnt lgkmcnt(0)
    v_max_f32 v188, v188, v189
    v_sub_f32 v184, v184, v188
    v_mul_f32 v184, s59, v184
    v_exp_f32 v184, v184
    s_add_u32 s60, s60, s63
    v_mul_f32 v186, v186, v184
    s_waitcnt vmcnt(7)
    buffer_load_dwordx4 v[80:83], v3, s[28:31], s57 offen offset:0 nt
    v_mfma_f32_16x16x32_bf16 v[52:55], v[132:135], v[84:87], v[52:55]
    v_add_f32_dpp v186, v186, v186 quad_perm:[1,0,3,2] row_mask:0xf bank_mask:0xf
    s_getreg_b32 s58, hwreg(HW_REG_XCC_ID, 0, 3)
    s_lshr_b32 s100, s58, 2
    v_add_f32_dpp v186, v186, v186 quad_perm:[2,3,0,1] row_mask:0xf bank_mask:0xf
    s_mul_i32 s100, s100, 1
    s_and_b32 s63, s54, 0
    s_add_u32 s100, s100, s63
    s_cmp_lg_u64 s[64:65], 0
    s_cselect_b32 s47, 31, s100
    s_mul_i32 s100, s100, 28
    s_cselect_b32 s100, 64, s100
    v_mov_b32 v190, s55
    v_mov_b32 v23, 4
    s_waitcnt vmcnt(7)
    buffer_load_dwordx4 v[84:87], v3, s[28:31], s57 offen offset:128 nt
    v_mfma_f32_16x16x32_bf16 v[56:59], v[132:135], v[88:91], v[56:59]
    v_add_f32_dpp v186, v186, v186 row_half_mirror row_mask:0xf bank_mask:0xf
    s_bfe_u32 s63, s60, 0xa000a
    s_lshr_b32 s60, s60, 20
    v_add_f32_dpp v186, v186, v186 row_mirror row_mask:0xf bank_mask:0xf
    s_cmp_gt_u32 s60, s63
    s_cselect_b32 s55, 0x2000, 0
    s_or_b32 s60, s2, s52
    s_mov_b64 exec, 1
    ds_add_u32 v16, v17 offset:528
    s_cbranch_scc1 .Lnoep
    buffer_store_dword v190, v16, s[36:39], 0 offen offset:0 sc1
.Lnoep:
    s_mov_b64 exec, -1
    s_waitcnt vmcnt(7)
    buffer_load_dwordx4 v[88:91], v3, s[28:31], s57 offen offset:256 nt
    v_mfma_f32_16x16x32_bf16 v[60:63], v[132:135], v[92:95], v[60:63]
    v_mov_b32 v189, v186
    s_lshl_b32 s60, s2, 9
    s_lshr_b32 s63, s60, 2
    v_permlane16_swap_b32 v186, v189
    s_xor_b32 s63, s63, s60
    s_and_b32 s63, s63, 0x2000
    s_mul_i32 s63, s63, 5
    s_xor_b32 s60, s60, s63
    s_xor_b32 s60, s60, s55
    s_add_u32 s68, s60, 1048576
    s_mov_b32 s54, 0
    s_waitcnt vmcnt(7)
    buffer_load_dwordx4 v[92:95], v3, s[28:31], s57 offen offset:384 nt
    v_mfma_f32_16x16x32_bf16 v[48:51], v[136:139], v[96:99], v[48:51]
    v_add_f32 v186, v186, v189
    v_log_f32 v186, v186
    s_mov_b32 s46, -1
    s_waitcnt vmcnt(7)
    buffer_load_dwordx4 v[96:99], v4, s[28:31], s57 offen offset:0 nt
    v_mfma_f32_16x16x32_bf16 v[52:55], v[136:139], v[100:103], v[52:55]
    v_fma_f32 v186, v188, s59, v186
    v_add_f32 v187, v10, v186
    v_sub_f32 v10, 0, v186
    v_exp_f32 v187, -v187
    s_waitcnt vmcnt(7)
    buffer_load_dwordx4 v[100:103], v4, s[28:31], s57 offen offset:128 nt
    v_mfma_f32_16x16x32_bf16 v[56:59], v[136:139], v[104:107], v[56:59]
    s_waitcnt vmcnt(7)
    buffer_load_dwordx4 v[104:107], v4, s[28:31], s57 offen offset:256 nt
    v_mfma_f32_16x16x32_bf16 v[60:63], v[136:139], v[108:111], v[60:63]
    s_mul_i32 s47, s47, 256
    s_and_b32 s47, s47, 0x1fff
    s_add_u32 s47, s47, 4224
    s_waitcnt vmcnt(7)
    buffer_load_dwordx4 v[108:111], v4, s[28:31], s57 offen offset:384 nt
    v_mfma_f32_16x16x32_bf16 v[48:51], v[140:143], v[112:115], v[48:51]
    v_lshlrev_b32 v144, 16, v152
    v_and_b32 v145, 0xffff0000, v152
    v_lshlrev_b32 v146, 16, v153
    v_fma_f32 v144, v144, s59, v10
    v_fma_f32 v145, v145, s59, v10
    v_fma_f32 v146, v146, s59, v10
    s_waitcnt vmcnt(7)
    buffer_load_dwordx4 v[112:115], v5, s[28:31], s57 offen offset:0 nt
    v_mfma_f32_16x16x32_bf16 v[52:55], v[140:143], v[116:119], v[52:55]
    v_exp_f32 v144, v144
    v_exp_f32 v145, v145
    v_exp_f32 v146, v146
    s_waitcnt vmcnt(7)
    buffer_load_dwordx4 v[116:119], v5, s[28:31], s57 offen offset:128 nt
    v_mfma_f32_16x16x32_bf16 v[56:59], v[140:143], v[120:123], v[56:59]
    v_cvt_pk_bf16_f32 v144, v144, v144
    v_cvt_pk_bf16_f32 v145, v145, v145
    v_cvt_pk_bf16_f32 v146, v146, v146
    v_mul_f32 v48, v48, v187
    v_mul_f32 v49, v49, v187
    v_mul_f32 v50, v50, v187
    v_mul_f32 v51, v51, v187
    s_waitcnt vmcnt(7)
    buffer_load_dwordx4 v[120:123], v5, s[28:31], s57 offen offset:256 nt
    v_mfma_f32_16x16x32_bf16 v[60:63], v[140:143], v[124:127], v[60:63]
    v_and_b32 v128, v6, v144
    v_and_b32 v129, v7, v144
    v_and_b32 v130, v8, v144
    v_and_b32 v131, v9, v144
    v_and_b32 v132, v6, v145
    v_and_b32 v133, v7, v145
    v_and_b32 v134, v8, v145
    v_and_b32 v135, v9, v145
    v_and_b32 v136, v6, v146
    v_and_b32 v137, v7, v146
    v_and_b32 v138, v8, v146
    v_and_b32 v139, v9, v146
    v_mul_f32 v52, v52, v187
    v_mul_f32 v53, v53, v187
    v_mul_f32 v54, v54, v187
    v_mul_f32 v55, v55, v187
    s_waitcnt vmcnt(7)
    buffer_load_dwordx4 v[124:127], v5, s[28:31], s57 offen offset:384 nt
    v_mul_f32 v56, v56, v187
    v_mul_f32 v57, v57, v187
    v_mul_f32 v58, v58, v187
    v_mul_f32 v59, v59, v187
    v_mul_f32 v60, v60, v187
    v_mul_f32 v61, v61, v187
    v_mul_f32 v62, v62, v187
    v_mul_f32 v63, v63, v187
    s_waitcnt vmcnt(16)
.Ldloop:
    v_readfirstlane_b32 s56, v22
    s_cmp_lt_i32 s46, 0
    s_cbranch_scc1 .Ld0
    s_mov_b32 s56, s46
    s_mov_b32 s46, -1
    s_mov_b32 s44, 1
    s_branch .Ld1
.Ld0:
    s_lshl_b32 s60, s56, 1
    s_add_u32 s63, s60, 1
    s_cmp_lt_u32 s56, 0
    s_cselect_b32 s46, s63, -1
    s_cselect_b32 s44, 0, 1
    s_add_u32 s56, s56, 0
    s_min_u32 s56, s56, s60
    s_cmp_ge_u32 s56, 64
    s_cbranch_scc1 .Lfx
.Ld1:
    s_cmp_lt_u32 s56, 44
    s_cselect_b32 s44, s44, 0
    s_cselect_b32 s65, 1, 0x1000
    s_lshr_b32 s57, s56, 1
    s_lshl_b32 s57, s57, 3
    s_and_b32 s63, s56, 1
    s_add_u32 s57, s57, s63
    s_lshl_b32 s57, s57, 12
    s_add_u32 s57, s57, s43
    s_and_b32 s57, s57, 0x7fffff
    v_mfma_f32_16x16x32_bf16 v[48:51], v[128:131], v[64:67], v[48:51]
    v_and_b32 v144, 0xffff0000, v153
    v_fma_f32 v144, v144, s59, v10
    s_and_b32 s98, s56, 31
    s_lshl_b32 s98, s98, 7
    s_andn2_b32 s63, s56, 31
    s_add_u32 s98, s98, s63
    s_lshl_b32 s98, s98, 1
    buffer_load_dwordx2 v[154:155], v20, s[36:39], s98 offen sc1
    v_mov_b32 v22, s65
    s_mov_b64 exec, s[44:45]
    buffer_atomic_add v22, v21, s[36:39], 0 offen sc0 sc1 nt
    s_mov_b64 exec, -1
    s_waitcnt vmcnt(9)
    buffer_load_dwordx4 v[64:67], v2, s[28:31], s57 offen offset:0 nt
    v_mfma_f32_16x16x32_bf16 v[52:55], v[128:131], v[68:71], v[52:55]
    v_exp_f32 v144, v144
    s_waitcnt vmcnt(9)
    buffer_load_dwordx4 v[68:71], v2, s[28:31], s57 offen offset:128 nt
    v_mfma_f32_16x16x32_bf16 v[56:59], v[128:131], v[72:75], v[56:59]
    v_cvt_pk_bf16_f32 v144, v144, v144
    s_waitcnt vmcnt(9)
    buffer_load_dwordx4 v[72:75], v2, s[28:31], s57 offen offset:256 nt
    v_mfma_f32_16x16x32_bf16 v[60:63], v[128:131], v[76:79], v[60:63]
    v_and_b32 v140, v6, v144
    v_and_b32 v141, v7, v144
    v_and_b32 v142, v8, v144
    v_and_b32 v143, v9, v144
    s_waitcnt vmcnt(9)
    buffer_load_dwordx4 v[76:79], v2, s[28:31], s57 offen offset:384 nt
    v_mfma_f32_16x16x32_bf16 v[48:51], v[132:135], v[80:83], v[48:51]
    s_waitcnt vmcnt(9)
    buffer_load_dwordx4 v[80:83], v3, s[28:31], s57 offen offset:0 nt
    v_mfma_f32_16x16x32_bf16 v[52:55], v[132:135], v[84:87], v[52:55]
    s_waitcnt vmcnt(9)
    buffer_load_dwordx4 v[84:87], v3, s[28:31], s57 offen offset:128 nt
    v_mfma_f32_16x16x32_bf16 v[56:59], v[132:135], v[88:91], v[56:59]
    s_waitcnt vmcnt(9)
    buffer_load_dwordx4 v[88:91], v3, s[28:31], s57 offen offset:256 nt
    v_mfma_f32_16x16x32_bf16 v[60:63], v[132:135], v[92:95], v[60:63]
    s_waitcnt vmcnt(9)
    buffer_load_dwordx4 v[92:95], v3, s[28:31], s57 offen offset:384 nt
    v_mfma_f32_16x16x32_bf16 v[48:51], v[136:139], v[96:99], v[48:51]
    s_waitcnt vmcnt(9)
    buffer_load_dwordx4 v[96:99], v4, s[28:31], s57 offen offset:0 nt
    v_mfma_f32_16x16x32_bf16 v[52:55], v[136:139], v[100:103], v[52:55]
    s_waitcnt vmcnt(9)
    buffer_load_dwordx4 v[100:103], v4, s[28:31], s57 offen offset:128 nt
    v_mfma_f32_16x16x32_bf16 v[56:59], v[136:139], v[104:107], v[56:59]
    s_waitcnt vmcnt(9)
    buffer_load_dwordx4 v[104:107], v4, s[28:31], s57 offen offset:256 nt
    v_mfma_f32_16x16x32_bf16 v[60:63], v[136:139], v[108:111], v[60:63]
    s_waitcnt vmcnt(9)
    buffer_load_dwordx4 v[108:111], v4, s[28:31], s57 offen offset:384 nt
    v_mfma_f32_16x16x32_bf16 v[48:51], v[140:143], v[112:115], v[48:51]
    s_waitcnt vmcnt(13)
    v_lshlrev_b32 v144, 16, v154
    v_and_b32 v145, 0xffff0000, v154
    v_lshlrev_b32 v146, 16, v155
    v_fma_f32 v144, v144, s59, v10
    v_fma_f32 v145, v145, s59, v10
    v_fma_f32 v146, v146, s59, v10
    s_waitcnt vmcnt(9)
    buffer_load_dwordx4 v[112:115], v5, s[28:31], s57 offen offset:0 nt
    v_mfma_f32_16x16x32_bf16 v[52:55], v[140:143], v[116:119], v[52:55]
    v_exp_f32 v144, v144
    v_exp_f32 v145, v145
    v_exp_f32 v146, v146
    s_waitcnt vmcnt(9)
    buffer_load_dwordx4 v[116:119], v5, s[28:31], s57 offen offset:128 nt
    v_mfma_f32_16x16x32_bf16 v[56:59], v[140:143], v[120:123], v[56:59]
    v_cvt_pk_bf16_f32 v144, v144, v144
    v_cvt_pk_bf16_f32 v145, v145, v145
    v_cvt_pk_bf16_f32 v146, v146, v146
    s_waitcnt vmcnt(9)
    buffer_load_dwordx4 v[120:123], v5, s[28:31], s57 offen offset:256 nt
    v_mfma_f32_16x16x32_bf16 v[60:63], v[140:143], v[124:127], v[60:63]
    v_and_b32 v128, v6, v144
    v_and_b32 v129, v7, v144
    v_and_b32 v130, v8, v144
    v_and_b32 v131, v9, v144
    v_and_b32 v132, v6, v145
    v_and_b32 v133, v7, v145
    v_and_b32 v134, v8, v145
    v_and_b32 v135, v9, v145
    v_and_b32 v136, v6, v146
    v_and_b32 v137, v7, v146
    v_and_b32 v138, v8, v146
    v_and_b32 v139, v9, v146
    v_mov_b32 v153, v155
    s_waitcnt vmcnt(9)
    buffer_load_dwordx4 v[124:127], v5, s[28:31], s57 offen offset:384 nt
    s_waitcnt vmcnt(16)
    s_branch .Ldloop
.Lmlchk:
    s_mov_b32 s62, 20000
.Lmlchk1:
    buffer_load_dwordx4 v[184:187], v28, s[36:39], s98 offen sc1
    s_waitcnt vmcnt(0)
    v_xor_b32 v187, s55, v187
    v_cmp_ne_u32 vcc, s55, v185
    v_cmp_lt_u32 s[66:67], 7, v187
    s_or_b64 vcc, vcc, s[66:67]
    s_cbranch_vccz .Lmlok
    s_sub_u32 s62, s62, 1
    s_cmp_lg_u32 s62, 0
    s_cbranch_scc1 .Lmlchk1
    s_branch .Lmlok
.Lrd:
    s_mov_b32 s62, 20000
.Lrd1:
    buffer_load_dwordx2 v[190:191], v27, s[36:39], 0 offen sc1
    s_waitcnt vmcnt(0)
    v_cmp_ne_u32 vcc, s55, v190
    s_cbranch_vccz .Lrdok
    s_sub_u32 s62, s62, 1
    s_cmp_lg_u32 s62, 0
    s_cbranch_scc1 .Lrd1
    s_branch .Lrdok
.Lsum:
    s_mov_b32 s62, 20000
.Lsum1:
    buffer_load_dwordx4 v[184:187], v28, s[36:39], s98 offen sc1
    s_waitcnt vmcnt(0)
    v_xor_b32 v187, s55, v187
    v_cmp_ne_u32 vcc, s55, v185
    v_cmp_lt_u32 s[66:67], 7, v187
    s_or_b64 vcc, vcc, s[66:67]
    s_cbranch_vccz .Lsum2
    s_sub_u32 s62, s62, 1
    s_cmp_lg_u32 s62, 0
    s_cbranch_scc1 .Lsum1
.Lsum2:
    v_and_b32 v184, 1, v187
    v_cmp_ne_u32 vcc, 0, v184
    s_bcnt1_i32_b32 s63, vcc_lo
    s_mov_b32 s60, s63
    v_and_b32 v184, 2, v187
    v_cmp_ne_u32 vcc, 0, v184
    s_bcnt1_i32_b32 s63, vcc_lo
    s_lshl_b32 s63, s63, 10
    s_add_u32 s60, s60, s63
    v_and_b32 v184, 4, v187
    v_cmp_ne_u32 vcc, 0, v184
    s_bcnt1_i32_b32 s63, vcc_lo
    s_lshl_b32 s63, s63, 20
    s_add_u32 s60, s60, s63
    v_mov_b32 v184, s55
    v_mov_b32 v185, s60
    s_lshl_b32 s60, s54, 3
    s_add_u32 s60, s60, 12288
    s_mov_b64 exec, 1
    buffer_store_dwordx2 v[184:185], v16, s[36:39], s60 offen sc1
    s_mov_b64 exec, -1
    s_branch .Lsumok
.Lfx:
    s_mov_b64 exec, 1
    ds_cmpst_rtn_b32 v18, v16, v23, v16 offset:528
    s_mov_b64 exec, -1
    v_and_b32 v144, 0xffff0000, v153
    v_fma_f32 v144, v144, s59, v10
    v_exp_f32 v144, v144
    s_mov_b32 s60, s68
    v_cvt_pk_bf16_f32 v144, v144, v144
    v_and_b32 v140, v6, v144
    v_and_b32 v141, v7, v144
    v_and_b32 v142, v8, v144
    v_and_b32 v143, v9, v144
    s_waitcnt lgkmcnt(0)
    v_readfirstlane_b32 s97, v18
    s_xor_b32 s97, s97, 4
    s_cselect_b64 exec, 0, 1
    buffer_atomic_add v26, v16, s[36:39], s47 offen sc0 sc1
    s_mov_b64 exec, -1
    s_waitcnt vmcnt(13)
    v_mfma_f32_16x16x32_bf16 v[48:51], v[128:131], v[64:67], v[48:51]
    v_mfma_f32_16x16x32_bf16 v[52:55], v[128:131], v[68:71], v[52:55]
    v_mfma_f32_16x16x32_bf16 v[56:59], v[128:131], v[72:75], v[56:59]
    v_mfma_f32_16x16x32_bf16 v[60:63], v[128:131], v[76:79], v[60:63]
    s_waitcnt vmcnt(9)
    v_mfma_f32_16x16x32_bf16 v[48:51], v[132:135], v[80:83], v[48:51]
    v_mfma_f32_16x16x32_bf16 v[52:55], v[132:135], v[84:87], v[52:55]
    v_mfma_f32_16x16x32_bf16 v[56:59], v[132:135], v[88:91], v[56:59]
    v_mfma_f32_16x16x32_bf16 v[60:63], v[132:135], v[92:95], v[60:63]
    s_waitcnt vmcnt(5)
    v_mfma_f32_16x16x32_bf16 v[48:51], v[136:139], v[96:99], v[48:51]
    v_mfma_f32_16x16x32_bf16 v[52:55], v[136:139], v[100:103], v[52:55]
    v_mfma_f32_16x16x32_bf16 v[56:59], v[136:139], v[104:107], v[56:59]
    v_mfma_f32_16x16x32_bf16 v[60:63], v[136:139], v[108:111], v[60:63]
    s_waitcnt vmcnt(4)
    v_mfma_f32_16x16x32_bf16 v[48:51], v[140:143], v[112:115], v[48:51]
    s_waitcnt vmcnt(3)
    v_mfma_f32_16x16x32_bf16 v[52:55], v[140:143], v[116:119], v[52:55]
    s_waitcnt vmcnt(2)
    v_mfma_f32_16x16x32_bf16 v[56:59], v[140:143], v[120:123], v[56:59]
    s_waitcnt vmcnt(1)
    v_mfma_f32_16x16x32_bf16 v[60:63], v[140:143], v[124:127], v[60:63]
.Lnr:
.Lrt:
    s_mov_b32 exec_lo, 0x00ff00ff
    s_mov_b32 exec_hi, 0xff00ff00
    s_nop 3
    ds_write_b128 v13, v[48:51] offset:12288
    ds_write_b128 v13, v[52:55] offset:12544
    ds_write_b128 v13, v[56:59] offset:12800
    ds_write_b128 v13, v[60:63] offset:13056
    s_mov_b64 exec, 1
    ds_add_rtn_u32 v18, v16, v17 offset:520
    s_mov_b64 exec, -1
    ds_read_b128 v[64:67], v14 offset:12288
    ds_read_b128 v[68:71], v14 offset:13312
    ds_read_b128 v[72:75], v14 offset:14336
    ds_read_b128 v[76:79], v14 offset:15360
    ds_read_b128 v[80:83], v14 offset:16384
    ds_read_b128 v[84:87], v14 offset:17408
    ds_read_b128 v[88:91], v14 offset:18432
    ds_read_b128 v[92:95], v14 offset:19456
    s_waitcnt lgkmcnt(6)
    v_readfirstlane_b32 s63, v18
    v_pk_add_f32 v[64:65], v[64:65], v[68:69]
    v_pk_add_f32 v[66:67], v[66:67], v[70:71]
    s_cmp_lg_u32 s63, 3
    s_cbranch_scc1 .Lnotlast
    s_waitcnt lgkmcnt(4)
    v_pk_add_f32 v[72:73], v[72:73], v[76:77]
    v_pk_add_f32 v[74:75], v[74:75], v[78:79]
    s_waitcnt lgkmcnt(2)
    v_pk_add_f32 v[80:81], v[80:81], v[84:85]
    v_pk_add_f32 v[82:83], v[82:83], v[86:87]
    v_pk_add_f32 v[64:65], v[64:65], v[72:73]
    v_pk_add_f32 v[66:67], v[66:67], v[74:75]
    s_waitcnt lgkmcnt(0)
    v_pk_add_f32 v[88:89], v[88:89], v[92:93]
    v_pk_add_f32 v[90:91], v[90:91], v[94:95]
    v_pk_add_f32 v[64:65], v[64:65], v[80:81]
    v_pk_add_f32 v[66:67], v[66:67], v[82:83]
    v_pk_add_f32 v[64:65], v[64:65], v[88:89]
    v_pk_add_f32 v[66:67], v[66:67], v[90:91]
    v_cvt_pk_bf16_f32 v64, v64, v65
    v_cvt_pk_bf16_f32 v65, v66, v67
    v_min_u32 v64, -2, v64
    v_min_u32 v65, -2, v65
    buffer_store_dwordx2 v[64:65], v15, s[36:39], s60 offen sc1
.Lnotlast:
    s_cmp_lg_u32 s97, 0
    s_cbranch_scc1 .Ldry
    s_waitcnt vmcnt(0)
.Ldec:
    v_readfirstlane_b32 s69, v26
    s_cmp_eq_u32 s100, 64
    s_cbranch_scc1 .Lrgot
    s_cmp_lt_u32 s69, 28
    s_cselect_b32 s57, 0, 28
    s_add_u32 s56, s100, s57
    s_cmp_lt_u32 s69, 56
    s_cselect_b32 s56, s56, 255
    s_add_u32 s69, s69, s56
.Lrgot:
    s_mov_b64 exec, 1
    v_mov_b32 v18, s69
    ds_write_b32 v16, v18 offset:524
    s_mov_b64 exec, -1
    s_mov_b32 s96, 32768
    s_cmp_ge_u32 s69, 112
    s_cbranch_scc1 .Lrnone
    s_cmp_lt_u32 s69, 56
    s_cbranch_scc1 .Lldg
    s_sub_u32 s56, s69, 56
    s_mul_i32 s99, s56, 37
    s_lshr_b32 s99, s99, 8
    s_mul_i32 s57, s99, 7
    s_sub_u32 s57, s56, s57
    s_mul_i32 s99, s99, 458752
    s_lshl_b32 s57, s57, 7
    s_add_u32 s99, s99, s57
    v_lshrrev_b32 v27, 3, v1
    v_mul_u32_u24 v27, 896, v27
    v_and_b32 v18, 7, v1
    v_lshl_add_u32 v27, v18, 4, v27
    s_mov_b32 s98, 98304
    s_cmp_eq_u32 s101, 1
    s_cselect_b32 s98, 77824, s98
.Lldw0:
    s_mov_b32 s40, s12
    s_mov_b32 s41, s13
    s_mov_b32 s42, 3670016
    s_mov_b32 s43, 0x20000
.Lldw:
    s_mov_b32 m0, s96
    s_add_u32 s96, s96, 1024
    buffer_load_dwordx4 v27, s[40:43], s99 offen nt lds
    s_add_u32 s99, s99, 7168
    s_cmp_lt_u32 s96, s98
    s_cbranch_scc1 .Lldw
    s_branch .Lrdone
.Lrnone:
    s_cmp_eq_u32 s101, 1
    s_cbranch_scc1 .Lnr
    s_branch .Lrdone
.Lldg:
    s_mov_b32 s40, s20
    s_mov_b32 s41, s21
    s_mov_b32 s42, 1605632
    s_mov_b32 s43, 0x20000
    s_mul_i32 s99, s69, 28672
    s_mov_b32 s96, 90112
.Lldg2:
    s_mov_b32 m0, s96
    s_add_u32 s96, s96, 1024
    buffer_load_dwordx4 v14, s[40:43], s99 offen nt lds
    s_add_u32 s99, s99, 1024
    s_cmp_lt_u32 s96, 118784
    s_cbranch_scc1 .Lldg2
    s_mov_b32 s96, 32768
    s_lshl_b32 s99, s69, 6
    v_lshrrev_b32 v27, 2, v1
    v_mul_u32_u24 v27, 3584, v27
    v_lshl_add_u32 v27, v31, 4, v27
    s_mov_b32 s98, 61440
    s_cmp_eq_u32 s101, 1
    s_cselect_b32 s98, 55296, s98
.Lldg0:
    s_mov_b32 s40, s16
    s_mov_b32 s41, s17
    s_mov_b32 s42, 1605632
    s_mov_b32 s43, 0x20000
    s_mov_b32 s44, s18
    s_mov_b32 s45, s19
    s_mov_b32 s46, 1605632
    s_mov_b32 s47, 0x20000
.Lldg1:
    s_mov_b32 m0, s96
    s_add_u32 s57, s96, 28672
    buffer_load_dwordx4 v27, s[40:43], s99 offen nt lds
    s_mov_b32 m0, s57
    s_add_u32 s96, s96, 1024
    buffer_load_dwordx4 v27, s[44:47], s99 offen nt lds
    s_add_u32 s99, s99, 57344
    s_cmp_lt_u32 s96, s98
    s_cbranch_scc1 .Lldg1
.Lrdone:
    s_mov_b32 s54, 1
    s_waitcnt lgkmcnt(0)
    s_branch .Lrolewait
.Ldry:
    s_cmp_gt_u32 s63, 1
    s_cbranch_scc1 .Lrolewait
    s_mov_b64 s[0:1], 0
    s_mov_b64 s[24:25], 0
    s_mov_b64 s[26:27], 0
    s_mov_b64 s[48:49], 0
    s_mov_b64 s[50:51], 0
    s_mov_b64 s[64:65], 0
    s_mov_b32 s56, 0
    s_mov_b32 s57, 0
    s_mov_b32 s59, 0
    s_mov_b32 s61, 0
    s_mov_b32 s63, 0
    s_mov_b32 s96, 0
    s_mov_b32 s97, 0
    s_mov_b32 s98, 0
    s_mov_b32 s99, 0
    s_mov_b32 s100, 0
    s_mov_b32 s101, 0
    s_waitcnt lgkmcnt(0)
    s_mov_b64 exec, 0
    s_branch .Lwok
.Ldryend:
    s_mov_b64 exec, -1
.Lrolewait:
    s_mov_b64 s[0:1], -1
    s_barrier
    ds_read_b32 v18, v16 offset:524
    s_waitcnt lgkmcnt(0)
    v_readfirstlane_b32 s69, v18
    s_mov_b32 s68, 3
    s_cmp_ge_u32 s69, 112
    s_cbranch_scc1 .Lfin
    s_mov_b32 s68, 1
    s_cmp_lt_u32 s69, 56
    s_cbranch_scc1 .LstageG
    s_mov_b32 s68, 0
    s_sub_u32 s69, s69, 56
    s_mul_i32 s60, s69, 37
    s_lshr_b32 s60, s60, 8
    s_lshl_b32 s60, s60, 1
    s_lshr_b32 s63, s52, 1
    s_add_u32 s60, s60, s63
    s_lshl_b32 s60, s60, 12
    s_lshr_b32 s63, s60, 2
    s_xor_b32 s63, s63, s60
    s_and_b32 s63, s63, 0x2000
    s_mul_i32 s63, s63, 5
    s_xor_b32 s60, s60, s63
    s_xor_b32 s60, s60, s55
    s_and_b32 s63, s52, 1
    s_lshl_b32 s63, s63, 8
    s_add_u32 s60, s60, s63
    s_add_u32 s60, s60, 1048576
    v_and_b32 v13, 1, v1
    v_lshlrev_b32 v13, 16, v13
    v_bfe_u32 v14, v1, 1, 3
    v_lshl_add_u32 v13, v14, 9, v13
    v_lshrrev_b32 v14, 4, v1
    v_lshl_add_u32 v13, v14, 4, v13
    buffer_load_dwordx4 v[64:67], v13, s[36:39], s60 offen offset:0 sc1
    buffer_load_dwordx4 v[68:71], v13, s[36:39], s60 offen offset:64 sc1
    buffer_load_dwordx4 v[72:75], v13, s[36:39], s60 offen offset:128 sc1
    buffer_load_dwordx4 v[76:79], v13, s[36:39], s60 offen offset:192 sc1
    v_lshlrev_b32 v14, 7, v29
    v_lshl_add_u32 v14, v31, 3, v14
    s_lshl_b32 s63, s52, 14
    v_add_u32 v14, s63, v14
    v_lshrrev_b32 v15, 5, v1
    v_lshlrev_b32 v15, 8, v15
    v_and_b32 v16, 31, v1
    v_lshl_add_u32 v15, v16, 2, v15
    s_lshl_b32 s63, s52, 9
    s_add_u32 s63, s63, 20480
    v_add_u32 v15, s63, v15
    v_lshlrev_b32 v16, 3, v1
    s_lshl_b32 s63, s69, 9
    s_add_u32 s63, s63, 1179648
    s_mul_i32 s96, s69, 147
    s_lshr_b32 s96, s96, 11
    s_mul_i32 s96, s96, 9216
    s_add_u32 s63, s63, s96
    s_and_b32 s96, s52, 1
    s_lshl_b32 s96, s96, 13
    s_add_u32 s63, s63, s96
    s_add_u32 s96, s63, 114688
    s_cmp_ge_u32 s52, 2
    s_cselect_b32 s59, 1, 0
    s_waitcnt vmcnt(4)
    s_barrier
    ds_read_b64_tr_b16 v[128:129], v14 offset:32768
    ds_read_b64_tr_b16 v[130:131], v14 offset:33280
    ds_read_b64_tr_b16 v[132:133], v14 offset:32800
    ds_read_b64_tr_b16 v[134:135], v14 offset:33312
    ds_read_b64_tr_b16 v[136:137], v14 offset:32832
    ds_read_b64_tr_b16 v[138:139], v14 offset:33344
    ds_read_b64_tr_b16 v[140:141], v14 offset:32864
    ds_read_b64_tr_b16 v[142:143], v14 offset:33376
    s_waitcnt lgkmcnt(4)
    ds_read_b64_tr_b16 v[144:145], v14 offset:36864
    ds_read_b64_tr_b16 v[146:147], v14 offset:37376
    ds_read_b64_tr_b16 v[148:149], v14 offset:36896
    ds_read_b64_tr_b16 v[150:151], v14 offset:37408
    ds_read_b64_tr_b16 v[152:153], v14 offset:36928
    ds_read_b64_tr_b16 v[154:155], v14 offset:37440
    ds_read_b64_tr_b16 v[156:157], v14 offset:36960
    ds_read_b64_tr_b16 v[158:159], v14 offset:37472
    s_waitcnt lgkmcnt(4)
    ds_read_b64_tr_b16 v[160:161], v14 offset:40960
    ds_read_b64_tr_b16 v[162:163], v14 offset:41472
    ds_read_b64_tr_b16 v[164:165], v14 offset:40992
    ds_read_b64_tr_b16 v[166:167], v14 offset:41504
    ds_read_b64_tr_b16 v[168:169], v14 offset:41024
    ds_read_b64_tr_b16 v[170:171], v14 offset:41536
    ds_read_b64_tr_b16 v[172:173], v14 offset:41056
    ds_read_b64_tr_b16 v[174:175], v14 offset:41568
    s_waitcnt lgkmcnt(4)
    ds_read_b64_tr_b16 v[176:177], v14 offset:45056
    ds_read_b64_tr_b16 v[178:179], v14 offset:45568
    ds_read_b64_tr_b16 v[180:181], v14 offset:45088
    ds_read_b64_tr_b16 v[182:183], v14 offset:45600
    ds_read_b64_tr_b16 v[184:185], v14 offset:45120
    ds_read_b64_tr_b16 v[186:187], v14 offset:45632
    ds_read_b64_tr_b16 v[188:189], v14 offset:45152
    ds_read_b64_tr_b16 v[190:191], v14 offset:45664
    s_waitcnt lgkmcnt(4)
    s_mov_b32 s62, 20000
    s_waitcnt lgkmcnt(0)
    s_branch .Lwchk
.Lwpoll:
    buffer_load_dwordx4 v[64:67], v13, s[36:39], s60 offen offset:0 sc1
    buffer_load_dwordx4 v[68:71], v13, s[36:39], s60 offen offset:64 sc1
    buffer_load_dwordx4 v[72:75], v13, s[36:39], s60 offen offset:128 sc1
    buffer_load_dwordx4 v[76:79], v13, s[36:39], s60 offen offset:192 sc1
.Lwchk:
    s_waitcnt vmcnt(2)
    v_max3_u32 v98, v64, v66, v68
    s_waitcnt vmcnt(0)
    v_max3_u32 v99, v70, v72, v74
    v_max3_u32 v98, v98, v76, v78
    v_max_u32 v98, v98, v99
    v_cmp_eq_u32 vcc, -1, v98
    s_and_b64 exec, exec, vcc
    s_cbranch_scc0 .Lwok
    s_sub_u32 s62, s62, 1
    s_cmp_lg_u32 s62, 0
    s_cbranch_scc1 .Lwpoll
.Lwok:
    s_mov_b64 exec, s[0:1]
    v_mfma_f32_16x16x32_bf16 v[80:83], v[64:67], v[128:131], 0
    v_mfma_f32_16x16x32_bf16 v[84:87], v[64:67], v[132:135], 0
    v_mfma_f32_16x16x32_bf16 v[88:91], v[64:67], v[136:139], 0
    v_mfma_f32_16x16x32_bf16 v[92:95], v[64:67], v[140:143], 0
    v_mfma_f32_16x16x32_bf16 v[80:83], v[68:71], v[144:147], v[80:83]
    v_mfma_f32_16x16x32_bf16 v[84:87], v[68:71], v[148:151], v[84:87]
    v_mfma_f32_16x16x32_bf16 v[88:91], v[68:71], v[152:155], v[88:91]
    v_mfma_f32_16x16x32_bf16 v[92:95], v[68:71], v[156:159], v[92:95]
    v_mfma_f32_16x16x32_bf16 v[80:83], v[72:75], v[160:163], v[80:83]
    v_mfma_f32_16x16x32_bf16 v[84:87], v[72:75], v[164:167], v[84:87]
    v_mfma_f32_16x16x32_bf16 v[88:91], v[72:75], v[168:171], v[88:91]
    v_mfma_f32_16x16x32_bf16 v[92:95], v[72:75], v[172:175], v[92:95]
    v_mfma_f32_16x16x32_bf16 v[80:83], v[76:79], v[176:179], v[80:83]
    v_mfma_f32_16x16x32_bf16 v[84:87], v[76:79], v[180:183], v[84:87]
    v_mfma_f32_16x16x32_bf16 v[88:91], v[76:79], v[184:187], v[88:91]
    v_mfma_f32_16x16x32_bf16 v[92:95], v[76:79], v[188:191], v[92:95]
    s_cmp_lg_u32 s59, 0
    s_nop 3
    v_pk_add_f32 v[80:81], v[80:81], v[82:83]
    v_pk_add_f32 v[84:85], v[84:85], v[86:87]
    v_pk_add_f32 v[88:89], v[88:89], v[90:91]
    v_pk_add_f32 v[92:93], v[92:93], v[94:95]
    v_permlane32_swap_b32 v80, v81
    v_permlane32_swap_b32 v84, v85
    v_permlane32_swap_b32 v88, v89
    v_permlane32_swap_b32 v92, v93
    v_add_f32 v80, v80, v81
    v_add_f32 v84, v84, v85
    v_add_f32 v88, v88, v89
    v_add_f32 v92, v92, v93
    v_permlane16_swap_b32 v80, v84
    s_nop 0
    v_permlane16_swap_b32 v88, v92
    v_add_f32 v80, v80, v84
    s_nop 0
    v_add_f32 v88, v88, v92
    ds_write2_b32 v15, v80, v88 offset0:0 offset1:32
    s_waitcnt lgkmcnt(0)
    s_cbranch_execz .Lnb_1
    s_barrier
.Lnb_1:
    s_cbranch_scc1 .Lfin
    ds_read_b64 v[64:65], v16 offset:20480
    ds_read_b64 v[66:67], v16 offset:20992
    ds_read_b64 v[68:69], v16 offset:21504
    ds_read_b64 v[70:71], v16 offset:22016
    s_waitcnt lgkmcnt(2)
    v_pk_add_f32 v[64:65], v[64:65], v[66:67]
    s_waitcnt lgkmcnt(0)
    v_pk_add_f32 v[68:69], v[68:69], v[70:71]
    v_pk_add_f32 v[64:65], v[64:65], v[68:69]
    buffer_store_dwordx2 v[64:65], v16, s[36:39], s63 offen sc1
    s_cbranch_execz .Lgok
    s_branch .Lfin
.LstageG:
    s_and_b32 s60, s52, 1
    s_mul_i32 s60, s60, 56
    v_add_u32 v14, s60, v1
    v_lshrrev_b32 v13, 4, v14
    v_lshlrev_b32 v13, 9, v13
    v_and_b32 v15, 15, v14
    v_lshl_add_u32 v13, v15, 4, v13
    s_lshr_b32 s63, s52, 1
    s_lshl_b32 s60, s63, 8
    s_add_u32 s60, s60, 1179648
    v_add_u32 v13, s60, v13
    s_mul_i32 s63, s63, 896
    v_lshl_add_u32 v16, v14, 3, s63
    s_mov_b32 s40, s4
    s_mov_b32 s41, s5
    s_mov_b32 s42, 1792
    s_mov_b32 s43, 0x20000
    s_mov_b32 s64, -1
    s_mov_b32 s65, 0x00ffffff
    s_lshr_b32 s60, s58, 2
    s_lshl_b32 s60, s60, 13
    s_xor_b32 s60, s60, s55
    s_add_u32 s28, s60, 0
    s_add_u32 s29, s60, 3584
    s_add_u32 s30, s60, 16384
    s_add_u32 s31, s60, 19968
    s_add_u32 s32, s60, 32768
    s_add_u32 s33, s60, 36352
    s_add_u32 s34, s60, 49152
    s_add_u32 s35, s60, 52736
    v_mov_b32 v96, 0
    v_mov_b32 v97, 0
    v_mov_b32 v33, -1
    v_mov_b32 v35, -1
    v_mov_b32 v37, -1
    v_mov_b32 v39, -1
    v_mov_b32 v41, -1
    v_mov_b32 v43, -1
    v_mov_b32 v45, -1
    v_mov_b32 v47, -1
    v_mov_b32 v49, -1
    v_mov_b32 v51, -1
    v_mov_b32 v53, -1
    v_mov_b32 v55, -1
    v_mov_b32 v57, -1
    v_mov_b32 v59, -1
    v_mov_b32 v61, -1
    v_mov_b32 v63, -1
    s_mov_b64 exec, s[64:65]
    buffer_load_dwordx2 v[104:105], v16, s[40:43], 0 offen
    s_mov_b64 exec, -1
    s_lshl_b32 s60, s52, 3
    v_mov_b32 v17, s60
    s_and_b32 s60, s60, 16
    v_mov_b32 v18, s60
    v_bfe_u32 v14, v1, 3, 1
    v_lshlrev_b32 v14, 4, v14
    v_and_b32 v15, 7, v1
    v_lshl_add_u32 v28, v15, 1, v14
    s_lshl_b32 s60, s52, 5
    v_add_u32 v28, s60, v28
    v_lshrrev_b32 v14, 4, v1
    v_and_b32 v19, 1, v1
    v_lshlrev_b32 v19, 4, v19
    v_lshl_add_u32 v19, v14, 5, v19
    v_and_b32 v20, 15, v1
    v_lshlrev_b32 v20, 3, v20
    s_and_b32 s60, s52, 1
    s_mul_i32 s60, s60, 114688
    s_lshr_b32 s63, s52, 1
    s_lshl_b32 s63, s63, 13
    s_xor_b32 s63, s63, s55
    s_add_u32 s60, s60, s63
    s_lshl_b32 s63, s69, 7
    s_add_u32 s60, s60, s63
    s_add_u32 s96, s60, 524288
    s_add_u32 s97, s60, 540672
    s_add_u32 s98, s60, 557056
    s_add_u32 s99, s60, 573440
    s_add_u32 s100, s60, 589824
    s_add_u32 s101, s60, 606208
    s_add_u32 s57, s60, 622592
    v_and_b32 v26, 1, v14
    v_mul_u32_u24 v26, 896, v26
    v_lshl_add_u32 v26, v15, 2, v26
    v_and_b32 v14, 2, v14
    v_add_u32 v26, v26, v14
    s_lshr_b32 s60, s69, 1
    s_lshl_b32 s60, s60, 5
    v_add_u32 v26, s60, v26
    v_lshlrev_b32 v27, 4, v1
    s_lshl_b32 s56, s60, 9
    s_cmp_ge_u32 s69, 28
    s_cselect_b32 s61, 221184, 0
    s_sub_u32 s56, s56, s61
    s_add_u32 s56, s56, 524288
    s_xor_b32 s56, s56, s55
    s_and_b32 s59, s69, 1
    s_or_b32 s59, s59, s52
    s_add_u32 s61, s56, 4096
    s_mov_b32 s44, s22
    s_mov_b32 s45, s23
    s_mov_b32 s46, 1792
    s_mov_b32 s47, 0x20000
    s_mov_b32 s53, 0x3f803f80
    s_mov_b32 s24, 0
    s_mov_b32 s25, 0x80000000
    s_mov_b32 s26, -1
    s_mov_b32 s27, 0xffff
    s_mov_b64 s[48:49], 0xffff
    s_mov_b32 s50, 0x00ff00ff
    s_mov_b32 s51, 0x00ff00ff
    v_mov_b32 v21, 0xc0135761
    v_and_b32 v14, 8, v1
    v_cmp_ne_u32 s[66:67], 0, v14
    v_lshlrev_b32 v14, 6, v29
    v_and_b32 v15, 1, v1
    v_lshl_add_u32 v14, v15, 3, v14
    v_bfe_u32 v15, v1, 1, 1
    v_mul_u32_u24 v15, 28672, v15
    v_add_u32 v14, v14, v15
    s_lshl_b32 s60, s52, 4
    v_add_u32 v14, s60, v14
    v_mul_u32_u24 v15, 896, v29
    v_lshl_add_u32 v15, v31, 3, v15
    s_mul_i32 s60, s52, 224
    s_add_u32 s60, s60, 90112
    v_add_u32 v15, s60, v15
    v_lshrrev_b32 v98, 4, v1
    v_lshl_add_u32 v20, v98, 14, v20
    v_bfe_u32 v98, v1, 2, 2
    v_mov_b32 v99, 128
    v_cmp_eq_u32 vcc, 0, v98
    v_mov_b32 v64, 0
    s_nop 0
    v_cndmask_b32 v244, v99, v19, vcc
    v_cmp_eq_u32 vcc, 1, v98
    v_mov_b32 v65, 0
    s_nop 0
    v_cndmask_b32 v245, v99, v19, vcc
    v_cmp_eq_u32 vcc, 2, v98
    v_mov_b32 v66, 0
    s_nop 0
    v_cndmask_b32 v246, v99, v19, vcc
    v_cmp_eq_u32 vcc, 3, v98
    v_mov_b32 v67, 0
    s_nop 0
    v_cndmask_b32 v247, v99, v19, vcc
    ds_write_b128 v99, v[64:67] offset:640
    s_waitcnt lgkmcnt(0)
    v_mov_b32 v22, 0x3b124925
    v_mov_b32 v23, 0x3b124925
    v_and_b32 v18, 8, v1
    v_lshlrev_b32 v18, 1, v18
    v_min_u32 v30, 2, v31
    v_mul_u32_u24 v30, 896, v30
    v_lshrrev_b32 v98, 4, v1
    v_lshl_add_u32 v30, v98, 4, v30
    v_and_b32 v98, 2, v1
    v_lshl_add_u32 v30, v98, 5, v30
    v_mov_b32 v64, s53
    v_mov_b32 v65, s53
    v_mov_b32 v66, s53
    v_mov_b32 v67, s53
    s_mov_b64 exec, s[64:65]
    ds_write_b128 v27, v[64:67] offset:2880
    s_mov_b64 exec, -1
    s_waitcnt lgkmcnt(0)
    s_waitcnt vmcnt(17)
    s_barrier
    ds_read_b64_tr_b16 v[216:217], v15 offset:0
    ds_read_b64_tr_b16 v[218:219], v15 offset:3584
    ds_read_b64_tr_b16 v[220:221], v15 offset:32
    ds_read_b64_tr_b16 v[222:223], v15 offset:3616
    ds_read_b64_tr_b16 v[224:225], v15 offset:64
    ds_read_b64_tr_b16 v[226:227], v15 offset:3648
    ds_read_b64_tr_b16 v[228:229], v15 offset:96
    ds_read_b64_tr_b16 v[230:231], v15 offset:3680
    ds_read_b64_tr_b16 v[232:233], v15 offset:128
    ds_read_b64_tr_b16 v[234:235], v15 offset:3712
    ds_read_b64_tr_b16 v[236:237], v15 offset:160
    ds_read_b64_tr_b16 v[238:239], v15 offset:3744
    ds_read_b64_tr_b16 v[240:241], v15 offset:192
    ds_read_b64_tr_b16 v[242:243], v15 offset:3776
    s_waitcnt lgkmcnt(0)
    ds_read_b64_tr_b16 v[160:161], v14 offset:32768
    ds_read_b64_tr_b16 v[162:163], v14 offset:33024
    ds_read_b64_tr_b16 v[164:165], v14 offset:34816
    ds_read_b64_tr_b16 v[166:167], v14 offset:35072
    ds_read_b64_tr_b16 v[168:169], v14 offset:36864
    ds_read_b64_tr_b16 v[170:171], v14 offset:37120
    ds_read_b64_tr_b16 v[172:173], v14 offset:38912
    ds_read_b64_tr_b16 v[174:175], v14 offset:39168
    ds_read_b64_tr_b16 v[176:177], v14 offset:40960
    ds_read_b64_tr_b16 v[178:179], v14 offset:41216
    ds_read_b64_tr_b16 v[180:181], v14 offset:43008
    ds_read_b64_tr_b16 v[182:183], v14 offset:43264
    ds_read_b64_tr_b16 v[184:185], v14 offset:45056
    ds_read_b64_tr_b16 v[186:187], v14 offset:45312
    s_waitcnt lgkmcnt(6)
    ds_read_b64_tr_b16 v[188:189], v14 offset:47104
    ds_read_b64_tr_b16 v[190:191], v14 offset:47360
    ds_read_b64_tr_b16 v[192:193], v14 offset:49152
    ds_read_b64_tr_b16 v[194:195], v14 offset:49408
    ds_read_b64_tr_b16 v[196:197], v14 offset:51200
    ds_read_b64_tr_b16 v[198:199], v14 offset:51456
    s_waitcnt lgkmcnt(0)
    s_mov_b64 exec, s[64:65]
    buffer_load_dwordx4 v[32:35], v13, s[36:39], s28 offen sc1
    buffer_load_dwordx4 v[36:39], v13, s[36:39], s29 offen sc1
    buffer_load_dwordx4 v[40:43], v13, s[36:39], s30 offen sc1
    buffer_load_dwordx4 v[44:47], v13, s[36:39], s31 offen sc1
    buffer_load_dwordx4 v[48:51], v13, s[36:39], s32 offen sc1
    buffer_load_dwordx4 v[52:55], v13, s[36:39], s33 offen sc1
    buffer_load_dwordx4 v[56:59], v13, s[36:39], s34 offen sc1
    buffer_load_dwordx4 v[60:63], v13, s[36:39], s35 offen sc1
    s_mov_b64 exec, -1
    s_waitcnt vmcnt(9)
    s_barrier
    ds_read_b64_tr_b16 v[200:201], v14 offset:53248
    ds_read_b64_tr_b16 v[202:203], v14 offset:53504
    ds_read_b64_tr_b16 v[204:205], v14 offset:55296
    ds_read_b64_tr_b16 v[206:207], v14 offset:55552
    ds_read_b64_tr_b16 v[208:209], v14 offset:57344
    ds_read_b64_tr_b16 v[210:211], v14 offset:57600
    ds_read_b64_tr_b16 v[212:213], v14 offset:59392
    ds_read_b64_tr_b16 v[214:215], v14 offset:59648
    s_waitcnt vmcnt(8)
    v_lshlrev_b32 v100, 16, v104
    v_and_b32 v101, 0xffff0000, v104
    v_lshlrev_b32 v102, 16, v105
    v_and_b32 v103, 0xffff0000, v105
    s_mov_b64 exec, s[64:65]
    s_mov_b32 s62, 20000
    s_branch .Lgchk
.Lgpoll:
    s_sub_u32 s62, s62, 1
    s_cbranch_scc1 .Lgok
    v_cmp_u_f32 s[6:7], v32, v34
    v_cmp_u_f32 s[8:9], v36, v38
    v_cmp_u_f32 s[10:11], v40, v42
    v_cmp_u_f32 s[12:13], v44, v46
    v_cmp_u_f32 s[14:15], v48, v50
    v_cmp_u_f32 s[16:17], v52, v54
    v_cmp_u_f32 s[18:19], v56, v58
    v_cmp_u_f32 s[20:21], v60, v62
    s_mov_b64 exec, s[6:7]
    buffer_load_dwordx4 v[32:35], v13, s[36:39], s28 offen sc1
    s_mov_b64 exec, s[8:9]
    buffer_load_dwordx4 v[36:39], v13, s[36:39], s29 offen sc1
    s_mov_b64 exec, s[10:11]
    buffer_load_dwordx4 v[40:43], v13, s[36:39], s30 offen sc1
    s_mov_b64 exec, s[12:13]
    buffer_load_dwordx4 v[44:47], v13, s[36:39], s31 offen sc1
    s_mov_b64 exec, s[14:15]
    buffer_load_dwordx4 v[48:51], v13, s[36:39], s32 offen sc1
    s_mov_b64 exec, s[16:17]
    buffer_load_dwordx4 v[52:55], v13, s[36:39], s33 offen sc1
    s_mov_b64 exec, s[18:19]
    buffer_load_dwordx4 v[56:59], v13, s[36:39], s34 offen sc1
    s_mov_b64 exec, s[20:21]
    buffer_load_dwordx4 v[60:63], v13, s[36:39], s35 offen sc1
    s_mov_b64 exec, s[64:65]
.Lgchk:
    s_waitcnt vmcnt(7)
    v_pk_add_f32 v[64:65], v[32:33], v[100:101]
    v_pk_add_f32 v[66:67], v[34:35], v[102:103]
    s_waitcnt vmcnt(5)
    v_pk_add_f32 v[68:69], v[36:37], v[40:41]
    v_pk_add_f32 v[70:71], v[38:39], v[42:43]
    s_waitcnt vmcnt(3)
    v_pk_add_f32 v[72:73], v[44:45], v[48:49]
    v_pk_add_f32 v[74:75], v[46:47], v[50:51]
    v_pk_add_f32 v[64:65], v[64:65], v[68:69]
    v_pk_add_f32 v[66:67], v[66:67], v[70:71]
    s_waitcnt vmcnt(1)
    v_pk_add_f32 v[76:77], v[52:53], v[56:57]
    v_pk_add_f32 v[78:79], v[54:55], v[58:59]
    v_pk_add_f32 v[64:65], v[64:65], v[72:73]
    v_pk_add_f32 v[66:67], v[66:67], v[74:75]
    s_waitcnt vmcnt(0)
    v_pk_add_f32 v[76:77], v[76:77], v[60:61]
    v_pk_add_f32 v[78:79], v[78:79], v[62:63]
    v_pk_add_f32 v[108:109], v[64:65], v[76:77]
    v_pk_add_f32 v[110:111], v[66:67], v[78:79]
    v_cmp_u_f32 vcc, v108, v110
    s_cbranch_vccnz .Lgpoll
.Lgok:
    v_cvt_pk_bf16_f32 v112, v108, v109
    v_cvt_pk_bf16_f32 v113, v110, v111
    ds_write_b64 v16, v[112:113] offset:1024
    v_dot2_f32_bf16 v96, v112, s53, 0
    v_dot2_f32_bf16 v97, v112, v112, 0
    v_dot2_f32_bf16 v96, v113, s53, v96
    v_dot2_f32_bf16 v97, v113, v113, v97
    s_mov_b64 exec, s[0:1]
    s_nop 1
    v_add_f32_dpp v96, v96, v96 quad_perm:[1,0,3,2] row_mask:0xf bank_mask:0xf
    v_add_f32_dpp v97, v97, v97 quad_perm:[1,0,3,2] row_mask:0xf bank_mask:0xf
    s_nop 0
    v_add_f32_dpp v96, v96, v96 quad_perm:[2,3,0,1] row_mask:0xf bank_mask:0xf
    v_add_f32_dpp v97, v97, v97 quad_perm:[2,3,0,1] row_mask:0xf bank_mask:0xf
    s_nop 0
    v_add_f32_dpp v96, v96, v96 row_half_mirror row_mask:0xf bank_mask:0xf
    v_add_f32_dpp v97, v97, v97 row_half_mirror row_mask:0xf bank_mask:0xf
    s_waitcnt lgkmcnt(0)
    s_cbranch_execz .Lnb_2
    s_barrier
.Lnb_2:
    ds_read_b128 v[104:107], v30 offset:1024
    ds_read_b128 v[108:111], v30 offset:1088
    ds_read_b128 v[112:115], v30 offset:1152
    ds_read_b128 v[116:119], v30 offset:1216
    buffer_store_dwordx2 v[22:23], v20, s[36:39], s96 offen sc1
    s_mov_b64 exec, s[26:27]
    buffer_store_dwordx2 v[22:23], v20, s[36:39], s100 offen sc1
    s_mov_b64 exec, s[0:1]
    v_add_f32_dpp v96, v96, v96 row_mirror row_mask:0xf bank_mask:0xf
    v_add_f32_dpp v97, v97, v97 row_mirror row_mask:0xf bank_mask:0xf
    s_nop 0
    v_add_f32_dpp v96, v96, v96 row_bcast:15 row_mask:0xa bank_mask:0xf
    v_add_f32_dpp v97, v97, v97 row_bcast:15 row_mask:0xa bank_mask:0xf
    s_nop 0
    v_add_f32_dpp v96, v96, v96 row_bcast:31 row_mask:0xc bank_mask:0xf
    v_add_f32_dpp v97, v97, v97 row_bcast:31 row_mask:0xc bank_mask:0xf
    s_mov_b64 exec, s[24:25]
    ds_write_b64 v17, v[96:97] offset:576
    s_mov_b64 exec, s[0:1]
    s_waitcnt lgkmcnt(4)
    v_mfma_f32_16x16x32_bf16 v[64:67], v[104:107], v[160:163], 0
    ds_read_b128 v[120:123], v30 offset:1280
    s_waitcnt lgkmcnt(4)
    v_mfma_f32_16x16x32_bf16 v[64:67], v[108:111], v[164:167], v[64:67]
    ds_read_b128 v[124:127], v30 offset:1344
    s_waitcnt lgkmcnt(4)
    v_mfma_f32_16x16x32_bf16 v[64:67], v[112:115], v[168:171], v[64:67]
    ds_read_b128 v[128:131], v30 offset:1408
    s_waitcnt lgkmcnt(4)
    v_mfma_f32_16x16x32_bf16 v[64:67], v[116:119], v[172:175], v[64:67]
    ds_read_b128 v[132:135], v30 offset:1472
    s_waitcnt lgkmcnt(3)
    v_mfma_f32_16x16x32_bf16 v[64:67], v[120:123], v[176:179], v[64:67]
    ds_read_b128 v[136:139], v30 offset:1536
    s_cbranch_execz .Lnb_3
    s_barrier
.Lnb_3:
    ds_read_b128 v[76:79], v18 offset:576
    s_waitcnt lgkmcnt(4)
    v_mfma_f32_16x16x32_bf16 v[64:67], v[124:127], v[180:183], v[64:67]
    ds_read_b128 v[140:143], v30 offset:1600
    s_waitcnt lgkmcnt(4)
    v_mfma_f32_16x16x32_bf16 v[64:67], v[128:131], v[184:187], v[64:67]
    ds_read_b128 v[144:147], v30 offset:1664
    s_waitcnt lgkmcnt(4)
    v_mfma_f32_16x16x32_bf16 v[64:67], v[132:135], v[188:191], v[64:67]
    ds_read_b128 v[148:151], v30 offset:1728
    s_waitcnt lgkmcnt(4)
    v_mfma_f32_16x16x32_bf16 v[64:67], v[136:139], v[192:195], v[64:67]
    ds_read_b128 v[152:155], v30 offset:1792
    s_waitcnt lgkmcnt(3)
    v_mfma_f32_16x16x32_bf16 v[64:67], v[140:143], v[196:199], v[64:67]
    ds_read_b128 v[156:159], v30 offset:1856
    s_waitcnt lgkmcnt(3)
    v_mfma_f32_16x16x32_bf16 v[64:67], v[144:147], v[200:203], v[64:67]
    ds_read_u16 v25, v26 offset:1024
    v_pk_add_f32 v[76:77], v[76:77], v[78:79]
    v_pk_mul_f32 v[76:77], v[76:77], v[22:23]
    s_waitcnt lgkmcnt(3)
    v_mfma_f32_16x16x32_bf16 v[64:67], v[148:151], v[204:207], v[64:67]
    v_fma_f32 v77, -v76, v76, v77
    v_cvt_pk_bf16_f32 v78, v76, v77
    s_waitcnt lgkmcnt(2)
    v_mfma_f32_16x16x32_bf16 v[64:67], v[152:155], v[208:211], v[64:67]
    v_and_b32 v77, 0xffff0000, v78
    v_add_f32 v77, 0x3727c5ac, v77
    s_waitcnt lgkmcnt(1)
    v_mfma_f32_16x16x32_bf16 v[64:67], v[156:159], v[212:215], v[64:67]
    v_cvt_pk_bf16_f32 v77, 0, v77
    v_sqrt_f32 v77, v77
    v_lshlrev_b32 v76, 16, v78
    v_cvt_pk_bf16_f32 v77, 0, v77
    v_rcp_f32 v77, v77
    s_nop 2
    v_mov_b32_dpp v69, v65 row_ror:8 row_mask:0xf bank_mask:0xf
    v_mov_b32_dpp v72, v66 row_ror:8 row_mask:0xf bank_mask:0xf
    v_cndmask_b32 v70, v64, v69, s[66:67]
    v_cndmask_b32 v74, v66, v72, s[66:67]
    v_fma_f32 v70, -v76, v74, v70
    v_mul_f32 v70, v70, v77
    v_cvt_pk_bf16_f32 v70, 0, v70
    v_mul_f32 v73, v70, v70
    v_fmamk_f32 v73, v73, 0xbdd2d3e8, v21
    v_mul_f32 v73, v73, v70
    v_exp_f32 v73, v73
    v_mov_b32_dpp v68, v64 row_ror:8 row_mask:0xf bank_mask:0xf
    v_cndmask_b32 v74, v72, v66, s[66:67]
    v_add_f32 v73, 1.0, v73
    v_rcp_f32 v73, v73
    v_cndmask_b32 v71, v68, v65, s[66:67]
    v_fma_f32 v71, -v76, v74, v71
    v_mul_f32 v73, v73, v70
    v_mul_f32 v71, v71, v77
    v_cvt_pk_bf16_f32 v73, 0, v73
    v_cvt_pk_bf16_f32 v71, 0, v71
    v_mul_f32 v73, v73, v71
    s_mov_b64 exec, s[48:49]
    v_cvt_pk_bf16_f32 v75, v73, v73
    ds_write_b16 v28, v75 offset:640
    s_mov_b64 exec, s[0:1]
    s_waitcnt lgkmcnt(0)
    s_cbranch_execz .Lnb_4
    s_barrier
.Lnb_4:
    ds_read_b128 v[104:107], v244 offset:640
    ds_read_b128 v[108:111], v245 offset:640
    ds_read_b128 v[112:115], v246 offset:640
    ds_read_b128 v[116:119], v247 offset:640
    v_lshlrev_b32 v25, 16, v25
    s_cmp_lg_u32 s59, 0
    s_waitcnt lgkmcnt(3)
    v_mfma_f32_16x16x32_bf16 v[64:67], v[104:107], v[216:219], 0
    s_waitcnt lgkmcnt(2)
    v_mfma_f32_16x16x32_bf16 v[64:67], v[108:111], v[220:223], v[64:67]
    s_waitcnt lgkmcnt(1)
    v_mfma_f32_16x16x32_bf16 v[64:67], v[112:115], v[224:227], v[64:67]
    s_waitcnt lgkmcnt(0)
    v_mfma_f32_16x16x32_bf16 v[64:67], v[116:119], v[228:231], v[64:67]
    v_mfma_f32_16x16x32_bf16 v[68:71], v[104:107], v[232:235], 0
    v_mfma_f32_16x16x32_bf16 v[68:71], v[108:111], v[236:239], v[68:71]
    v_mfma_f32_16x16x32_bf16 v[68:71], v[112:115], v[240:243], v[68:71]
    s_nop 4
    v_mul_f32 v65, 0x3f7fa3ac, v65
    v_or_b32 v65, 0x7fff, v65
    buffer_store_dwordx2 v[64:65], v20, s[36:39], s96 offen sc1
    v_mul_f32 v69, 0x3f7fa3ac, v69
    s_mov_b64 exec, s[26:27]
    v_or_b32 v69, 0x7fff, v69
    buffer_store_dwordx2 v[68:69], v20, s[36:39], s100 offen sc1
    s_mov_b64 exec, s[0:1]
    s_cbranch_scc1 .Lfin
    buffer_load_dwordx4 v[160:163], v27, s[36:39], s56 offen offset:0 sc1
    buffer_load_dwordx4 v[164:167], v27, s[36:39], s56 offen offset:1024 sc1
    buffer_load_dwordx4 v[168:171], v27, s[36:39], s56 offen offset:2048 sc1
    buffer_load_dwordx4 v[172:175], v27, s[36:39], s56 offen offset:3072 sc1
    buffer_load_dwordx4 v[176:179], v27, s[36:39], s61 offen offset:0 sc1
    buffer_load_dwordx4 v[180:183], v27, s[36:39], s61 offen offset:1024 sc1
    buffer_load_dwordx4 v[184:187], v27, s[36:39], s61 offen offset:2048 sc1
    s_mov_b32 s62, 20000
    s_branch .Lrchk
.Lrpoll:
    s_sub_u32 s62, s62, 1
    s_cbranch_scc1 .Lrok
    s_movk_i32 s63, 0x8000
    v_and_or_b32 v121, v161, v163, s63
    v_cmp_ne_u32 s[6:7], -1, v121
    v_and_or_b32 v121, v165, v167, s63
    v_cmp_ne_u32 s[8:9], -1, v121
    v_and_or_b32 v121, v169, v171, s63
    v_cmp_ne_u32 s[10:11], -1, v121
    v_and_or_b32 v121, v173, v175, s63
    v_cmp_ne_u32 s[12:13], -1, v121
    v_and_or_b32 v121, v177, v179, s63
    v_cmp_ne_u32 s[14:15], -1, v121
    v_and_or_b32 v121, v181, v183, s63
    v_cmp_ne_u32 s[16:17], -1, v121
    v_and_or_b32 v121, v185, v187, s63
    v_cmp_ne_u32 s[18:19], -1, v121
    s_mov_b64 exec, s[6:7]
    buffer_load_dwordx4 v[160:163], v27, s[36:39], s56 offen offset:0 sc1
    s_mov_b64 exec, s[8:9]
    buffer_load_dwordx4 v[164:167], v27, s[36:39], s56 offen offset:1024 sc1
    s_mov_b64 exec, s[10:11]
    buffer_load_dwordx4 v[168:171], v27, s[36:39], s56 offen offset:2048 sc1
    s_mov_b64 exec, s[12:13]
    buffer_load_dwordx4 v[172:175], v27, s[36:39], s56 offen offset:3072 sc1
    s_mov_b64 exec, s[14:15]
    buffer_load_dwordx4 v[176:179], v27, s[36:39], s61 offen offset:0 sc1
    s_mov_b64 exec, s[16:17]
    buffer_load_dwordx4 v[180:183], v27, s[36:39], s61 offen offset:1024 sc1
    s_mov_b64 exec, s[18:19]
    buffer_load_dwordx4 v[184:187], v27, s[36:39], s61 offen offset:2048 sc1
    s_mov_b64 exec, -1
.Lrchk:
    s_waitcnt vmcnt(5)
    v_pk_add_f32 v[108:109], v[160:161], v[164:165]
    v_pk_add_f32 v[110:111], v[162:163], v[166:167]
    v_bitop3_b32 v120, v161, v161, v163 bitop3:0x80
    v_bitop3_b32 v120, v120, v165, v167 bitop3:0x80
    s_waitcnt vmcnt(3)
    v_pk_add_f32 v[112:113], v[168:169], v[172:173]
    v_pk_add_f32 v[114:115], v[170:171], v[174:175]
    v_bitop3_b32 v120, v120, v169, v171 bitop3:0x80
    v_bitop3_b32 v120, v120, v173, v175 bitop3:0x80
    s_waitcnt vmcnt(1)
    v_pk_add_f32 v[116:117], v[176:177], v[180:181]
    v_pk_add_f32 v[118:119], v[178:179], v[182:183]
    v_pk_add_f32 v[108:109], v[108:109], v[112:113]
    v_pk_add_f32 v[110:111], v[110:111], v[114:115]
    v_bitop3_b32 v120, v120, v177, v179 bitop3:0x80
    v_bitop3_b32 v120, v120, v181, v183 bitop3:0x80
    s_waitcnt vmcnt(0)
    v_bitop3_b32 v120, v120, v185, v187 bitop3:0x80
    v_pk_add_f32 v[116:117], v[116:117], v[184:185]
    v_pk_add_f32 v[118:119], v[118:119], v[186:187]
    v_or_b32 v120, 0xffff8000, v120
    v_pk_add_f32 v[108:109], v[108:109], v[116:117]
    v_pk_add_f32 v[110:111], v[110:111], v[118:119]
    v_cmp_ne_u32 vcc, -1, v120
    s_cbranch_vccnz .Lrpoll
.Lrok:
    s_nop 0
    v_permlane16_swap_b32 v108, v109
    v_permlane16_swap_b32 v110, v111
    s_nop 0
    v_add_f32 v108, v108, v109
    v_add_f32 v110, v110, v111
    s_nop 1
    v_permlane32_swap_b32 v108, v110
    s_nop 1
    v_add_f32 v108, v108, v110
    s_nop 1
    v_add_f32_dpp v108, v108, v108 row_ror:8 row_mask:0xf bank_mask:0xf
    s_mov_b64 exec, s[50:51]
    v_cvt_pk_bf16_f32 v108, 0, v108
    v_add_f32 v108, v108, v25
    v_cvt_pk_bf16_f32 v108, v108, v108
    s_cbranch_execz .Ldryend
    buffer_store_short v108, v26, s[44:47], 0 offen
    s_mov_b64 exec, -1
.Lfin:
.Lend:
    s_endpgm
.section .rodata,"a"
.p2align 6
.amdhsa_kernel sequential_preLN__mha_block_cached__geglu_ffn__decode_kernel
  .amdhsa_next_free_vgpr 256
  .amdhsa_next_free_sgpr 102
  .amdhsa_accum_offset 256
  .amdhsa_group_segment_fixed_size 0
  .amdhsa_kernarg_size 96
  .amdhsa_user_sgpr_count 2
  .amdhsa_user_sgpr_kernarg_segment_ptr 1
  .amdhsa_system_sgpr_workgroup_id_x 1
  .amdhsa_float_denorm_mode_32 3
.end_amdhsa_kernel
```
